```python
import torch

def _softmax(x, axis=-1):
    return torch.softmax(x, dim=axis)
def _gelu(x):
    return torch.nn.functional.gelu(x, approximate="tanh")
def _silu(x):
    return torch.nn.functional.silu(x)
def _sigmoid(x):
    return torch.sigmoid(x)
def _layernorm(x, axis=-1, eps=1e-5):
    m = x.mean(dim=axis, keepdim=True)
    v = x.var(dim=axis, keepdim=True, unbiased=False)
    return (x - m) / torch.sqrt(v + eps)
def _scatter_add(tgt, idx, src, axis=0):
    return tgt.clone().index_add_(axis, idx, src)
def _segment_sum(src, seg, n):
    out = torch.zeros((n,) + src.shape[1:], dtype=src.dtype)
    return out.index_add_(0, seg, src)
def _pad(x, pw):
    flat = tuple(v for pair in reversed(pw) for v in pair)
    return torch.nn.functional.pad(x, flat)

kernel_name = 'parallel_sum__sliding_block__dense_activation_gelu__prompt'

def setup_inputs():

    _w = (lambda a: (lambda t: t.to(torch.bfloat16) if t.is_floating_point() else t)(torch.as_tensor(a)))
    def _A_setup():
        B, S, D = 1, 2048, 448
        return {
            "x": _w((lambda *s: torch.randn(*s, dtype=torch.bfloat16) * 0.05)(B, S, D)),
            "wqkv": _w((lambda *s: torch.randn(*s, dtype=torch.bfloat16) * 0.05)(D, 3 * D)),
            "wo": _w((lambda *s: torch.randn(*s, dtype=torch.bfloat16) * 0.05)(D, D)),
        }
    _A_in = _A_setup()

    def _B_setup():
        B, S, D, F = 1, 2048, 448, 1792
        return {
            "x": _w((lambda *s: torch.randn(*s, dtype=torch.bfloat16) * 0.05)(B, S, D)),
            "w1": _w((lambda *s: torch.randn(*s, dtype=torch.bfloat16) * 0.8)(D, F) * (D ** -0.5)),
            "b1": _w((lambda *s: torch.randn(*s, dtype=torch.bfloat16) * 0.8)(F) * 0.01),
            "w2": _w((lambda *s: torch.randn(*s, dtype=torch.bfloat16) * 0.8)(F, D) * (F ** -0.5)),
            "b2": _w((lambda *s: torch.randn(*s, dtype=torch.bfloat16) * 0.8)(D) * 0.01),
        }
    _B_in = _B_setup()

    return {
        "A_x": _A_in["x"],
        "A_wqkv": _A_in["wqkv"],
        "A_wo": _A_in["wo"],
        "B_x": _B_in["x"],
        "B_w1": _B_in["w1"],
        "B_b1": _B_in["b1"],
        "B_w2": _B_in["w2"],
        "B_b2": _B_in["b2"],
    }

def reference(A_x, A_wqkv, A_wo, B_x, B_w1, B_b1, B_w2, B_b2):
    def _A_ref(x, wqkv, wo):
        B, S, D = x.shape
        H = 16; Dh = D // H; W = 256
        qkv = (lambda x, *d: x.permute(*d))((x @ wqkv).reshape(B, S, 3, H, Dh), 2, 0, 3, 1, 4)
        q, k, v = qkv[0], qkv[1], qkv[2]
        scores = torch.einsum("bhqd,bhkd->bhqk", q, k) * (Dh ** -0.5)
        idx = torch.arange(S)
        mask = (idx[:, None] - idx[None, :] >= 0) & (idx[:, None] - idx[None, :] < W)
        scores = torch.where(mask[None, None], scores, -1e9)
        p = _softmax(scores, axis=-1)
        o = torch.einsum("bhqk,bhkd->bhqd", p, v)
        return (lambda x, *d: x.permute(*d))(o, 0, 2, 1, 3).reshape(B, S, D) @ wo

    def _B_ref(x, w1, b1, w2, b2):
        h = torch.einsum("bsd,df->bsf", x, w1) + b1
        h = _gelu(h)
        return torch.einsum("bsf,fd->bsd", h, w2) + b2

    x = A_x
    xn = _layernorm(x, axis=-1)
    return x + _A_ref(xn, A_wqkv, A_wo) + _B_ref(xn, B_w1, B_b1, B_w2, B_b2)
```

```asm
; @launch grid=(256,1,1) block=(512,1,1) lds=163840
.amdgcn_target "amdgcn-amd-amdhsa--gfx950"
.text
.globl parallel_sum__sliding_block__dense_activation_gelu__prompt_kernel
.p2align 8
.type parallel_sum__sliding_block__dense_activation_gelu__prompt_kernel,@function
parallel_sum__sliding_block__dense_activation_gelu__prompt_kernel:
    s_cmp_ge_u32 s2, 256
    s_cbranch_scc1 L_END
    s_load_dwordx16 s[4:19], s[0:1], 0
    s_load_dwordx4 s[20:23], s[0:1], 64
    s_load_dwordx2 s[24:25], s[0:1], 80
    v_lshrrev_b32 v2, 6, v0
    v_and_b32 v1, 63, v0
    v_readfirstlane_b32 s3, v2
    s_and_b32 s52, s2, 7
    s_lshr_b32 s53, s2, 3
    s_lshr_b32 s48, s52, 1
    s_lshl_b32 s48, s48, 2
    s_and_b32 s27, s53, 3
    s_add_u32 s48, s48, s27
    s_and_b32 s51, s52, 1
    s_lshl_b32 s49, s51, 3
    s_lshr_b32 s27, s53, 2
    s_add_u32 s49, s49, s27
    s_and_b32 s56, s27, 3
    s_and_b32 s55, s48, 7
    s_cmp_ge_u32 s53, 28
    s_cselect_b32 s50, 7, 6
    s_cselect_b32 s51, s51, 0
    s_and_b32 s26, s3, 3
    s_sub_u32 s27, s49, 7
    s_cmp_lt_u32 s27, 7
    s_cselect_b32 s54, 5, 0
    s_cmp_lt_u32 s49, 5
    s_cselect_b32 s27, 0, 10
    s_lshl_b32 s27, s27, 4
    s_or_b32 s54, s54, s27
    s_or_b32 s54, s54, 0xaa00
    s_cmp_eq_u32 s49, 7
    s_cselect_b32 s57, 14, s49
    s_cmp_eq_u32 s49, 14
    s_cselect_b32 s57, 7, s57
    s_lshl_b32 s58, s48, 2
    s_add_u32 s58, s58, s26
    v_and_b32 v2, 31, v1
    v_lshrrev_b32 v3, 5, v1
    s_cmp_ge_u32 s3, 4
    s_cbranch_scc1 L_AUX
    v_lshrrev_b32 v8, 3, v1
    v_and_b32 v9, 7, v1
    v_lshrrev_b32 v4, 4, v1
    v_xor_b32 v9, v9, v4
    v_mul_u32_u24 v8, 896, v8
    v_lshl_add_u32 v8, v9, 4, v8
    v_xor_b32 v9, 64, v8
    s_add_u32 s27, s56, 0
    s_and_b32 s27, s27, 3
    s_mulk_i32 s27, 7168
    s_add_u32 s27, s27, 4096
    v_add_u32 v4, s27, v8
    s_add_u32 s27, s56, 1
    s_and_b32 s27, s27, 3
    s_mulk_i32 s27, 7168
    s_add_u32 s27, s27, 3072
    v_add_u32 v5, s27, v9
    s_add_u32 s27, s56, 2
    s_and_b32 s27, s27, 3
    s_mulk_i32 s27, 7168
    s_add_u32 s27, s27, 2048
    v_add_u32 v6, s27, v8
    s_add_u32 s27, s56, 3
    s_and_b32 s27, s27, 3
    s_mulk_i32 s27, 7168
    s_add_u32 s27, s27, 1024
    v_add_u32 v7, s27, v9
    s_mul_i32 s59, s58, 28672
    s_mul_i32 s60, s3, 28672
    s_waitcnt lgkmcnt(0)
    s_sub_u32 s32, s4, 4096
    s_subb_u32 s33, s5, 0
    s_mov_b32 s34, 1839104
    s_mov_b32 s35, 0x20000
    s_add_u32 m0, s60, 0
    s_add_u32 s61, s59, 0
    buffer_load_dwordx4 v4, s[32:35], s61 offen lds
    s_add_u32 m0, s60, 4096
    s_add_u32 s61, s59, 128
    buffer_load_dwordx4 v4, s[32:35], s61 offen lds
    s_add_u32 m0, s60, 8192
    s_add_u32 s61, s59, 256
    buffer_load_dwordx4 v4, s[32:35], s61 offen lds
    s_add_u32 m0, s60, 12288
    s_add_u32 s61, s59, 384
    buffer_load_dwordx4 v4, s[32:35], s61 offen lds
    s_add_u32 m0, s60, 16384
    s_add_u32 s61, s59, 512
    buffer_load_dwordx4 v4, s[32:35], s61 offen lds
    s_add_u32 m0, s60, 20480
    s_add_u32 s61, s59, 640
    buffer_load_dwordx4 v4, s[32:35], s61 offen lds
    s_add_u32 m0, s60, 24576
    s_add_u32 s61, s59, 768
    buffer_load_dwordx4 v4, s[32:35], s61 offen lds
    s_add_u32 m0, s60, 0
    s_add_u32 s61, s59, 0
    buffer_load_dwordx4 v5, s[32:35], s61 offen offset:1024 lds
    buffer_load_dwordx4 v6, s[32:35], s61 offen offset:2048 lds
    buffer_load_dwordx4 v7, s[32:35], s61 offen offset:3072 lds
    s_add_u32 m0, s60, 4096
    s_add_u32 s61, s59, 128
    buffer_load_dwordx4 v5, s[32:35], s61 offen offset:1024 lds
    buffer_load_dwordx4 v6, s[32:35], s61 offen offset:2048 lds
    buffer_load_dwordx4 v7, s[32:35], s61 offen offset:3072 lds
    s_add_u32 m0, s60, 8192
    s_add_u32 s61, s59, 256
    buffer_load_dwordx4 v5, s[32:35], s61 offen offset:1024 lds
    buffer_load_dwordx4 v6, s[32:35], s61 offen offset:2048 lds
    buffer_load_dwordx4 v7, s[32:35], s61 offen offset:3072 lds
    s_lshl_b32 s27, s56, 3
    v_subrev_u32 v9, s27, v2
    v_and_b32 v9, 31, v9
    v_bfe_u32 v8, v9, 1, 3
    v_xor_b32 v8, v8, v3
    v_lshlrev_b32 v8, 4, v8
    v_lshl_add_u32 v8, v9, 7, v8
    v_add_u32 v8, s60, v8
    v_xor_b32 v9, 32, v8
    v_xor_b32 v10, 64, v8
    v_xor_b32 v11, 96, v8
    v_bfe_u32 v12, v1, 2, 1
    v_bfe_u32 v13, v1, 3, 1
    v_bfe_u32 v14, v1, 1, 1
    v_lshl_add_u32 v13, v13, 1, v14
    v_bfe_u32 v14, v1, 4, 1
    v_lshl_add_u32 v13, v14, 2, v13
    v_xor_b32 v12, v12, v3
    v_lshl_add_u32 v13, v12, 3, v13
    v_and_b32 v14, 1, v1
    v_lshlrev_b32 v14, 4, v14
    v_mov_b32 v15, 0x3f80
    v_lshlrev_b32 v14, v14, v15
    v_cmp_eq_u32 s[64:65], 0, v13
    v_cmp_eq_u32 s[66:67], 1, v13
    v_cmp_eq_u32 s[68:69], 2, v13
    v_cmp_eq_u32 s[70:71], 3, v13
    v_cmp_eq_u32 s[72:73], 4, v13
    v_cmp_eq_u32 s[74:75], 5, v13
    v_cmp_eq_u32 s[76:77], 6, v13
    v_cmp_eq_u32 s[78:79], 7, v13
    v_cndmask_b32 v96, 0, v14, s[64:65]
    v_cndmask_b32 v97, 0, v14, s[66:67]
    v_cndmask_b32 v98, 0, v14, s[68:69]
    v_cndmask_b32 v99, 0, v14, s[70:71]
    v_cndmask_b32 v100, 0, v14, s[72:73]
    v_cndmask_b32 v101, 0, v14, s[74:75]
    v_cndmask_b32 v102, 0, v14, s[76:77]
    v_cndmask_b32 v103, 0, v14, s[78:79]
    v_and_b32 v13, 3, v1
    v_bfe_u32 v14, v1, 4, 1
    v_lshl_add_u32 v13, v14, 2, v13
    v_bfe_u32 v14, v1, 2, 2
    v_lshlrev_b32 v14, 6, v14
    v_lshl_add_u32 v13, v13, 3, v14
    v_lshl_add_u32 v12, v3, 10, v13
    v_add_u32 v12, 32768, v12
    s_lshl_b32 s70, s52, 1
    s_and_b32 s27, s53, 1
    s_add_u32 s70, s70, s27
    s_lshr_b32 s27, s53, 1
    s_lshl_b32 s27, s27, 2
    s_add_u32 s71, s27, s3
    s_mul_i32 s73, s3, 3
    s_add_u32 s72, s27, s73
    s_sub_u32 s72, s72, 8
    s_lshl_b32 s73, s73, 12
    s_sub_u32 s87, s50, 6
    s_mul_i32 s87, s87, 57344
    s_add_u32 s87, s87, 32768
    s_add_u32 s73, s73, s87
    s_mul_i32 s78, s70, 1792
    s_mul_i32 s74, s71, 28672
    s_add_u32 s74, s74, s78
    s_add_u32 s27, s72, 0
    s_mul_i32 s75, s27, 28672
    s_add_u32 s75, s75, s78
    s_cmp_lt_i32 s27, 0
    s_cselect_b32 s75, 0x40000000, s75
    s_add_u32 s27, s72, 1
    s_mul_i32 s76, s27, 28672
    s_add_u32 s76, s76, s78
    s_cmp_lt_i32 s27, 0
    s_cselect_b32 s76, 0x40000000, s76
    s_add_u32 s27, s72, 2
    s_mul_i32 s77, s27, 28672
    s_add_u32 s77, s77, s78
    s_cmp_lt_i32 s27, 0
    s_cselect_b32 s77, 0x40000000, s77
    s_mul_i32 s27, s70, 28
    s_lshr_b32 s79, s27, 5
    s_add_u32 s27, s27, 27
    s_lshr_b32 s27, s27, 5
    s_sub_u32 s27, s27, s79
    v_and_b32 v13, 1, v1
    v_mul_u32_u24 v13, s27, v13
    v_add_u32 v13, s79, v13
    v_bfe_u32 v14, v1, 1, 2
    v_min_u32 v14, 2, v14
    v_add_u32 v14, s72, v14
    v_max_i32 v14, 0, v14
    v_mul_u32_u24 v14, 114, v14
    v_add_u32 v56, v13, v14
    v_bfe_u32 v14, v1, 3, 1
    v_mul_u32_u24 v14, 14, v14
    v_add_u32 v56, v56, v14
    v_lshlrev_b32 v56, 7, v56
    v_add_u32 v56, 14944000, v56
    s_mul_i32 s27, s71, 114
    v_add_u32 v13, s27, v13
    v_lshlrev_b32 v13, 7, v13
    v_add_u32 v57, 14942208, v13
    v_lshlrev_b32 v59, 3, v1
    s_sub_u32 s86, s50, 1
    s_mov_b32 s28, s24
    s_mov_b32 s29, s25
    s_mov_b32 s30, 15876224
    s_mov_b32 s31, 0x20000
    v_mov_b32 v14, 0
    v_mov_b32 v15, 0
    s_mov_b32 s62, 0x3f803f80
    s_mov_b32 s82, 0
    v_lshlrev_b32 v13, 7, v1
    s_mov_b32 s39, 0x20000
    s_cmp_eq_u32 s3, 0
    s_cbranch_scc0 M_T1
    s_sub_u32 s80, s2, 196
    s_cmp_lt_u32 s2, 196
    s_cselect_b32 s80, s2, s80
    s_cselect_b32 s36, s16, s8
    s_cselect_b32 s37, s17, s9
    s_mov_b32 s38, 401408
    s_cselect_b32 s38, 1605632, s38
    s_lshl_b32 s80, s80, 13
    s_branch M_TD
M_T1:
    s_cmp_eq_u32 s3, 3
    s_cbranch_scc0 M_T2
    s_cmp_eq_u32 s50, 7
    s_cbranch_scc1 M_T3
    s_getpc_b64 s[36:37]
M_PC:
    s_sub_u32 s36, s36, M_PC-parallel_sum__sliding_block__dense_activation_gelu__prompt_kernel
    s_subb_u32 s37, s37, 0
    s_mov_b32 s38, L_CODE_END-parallel_sum__sliding_block__dense_activation_gelu__prompt_kernel
    s_and_b32 s80, s53, 3
    s_lshl_b32 s80, s80, 13
    s_branch M_TD
M_T2:
    s_mul_i32 s27, s55, 56
    v_min_u32 v13, 55, v1
    v_add_u32 v13, s27, v13
    s_add_u32 s80, s57, 11
    s_sub_u32 s27, s49, 5
    s_cmp_eq_u32 s3, 1
    s_cselect_b32 s80, s27, s80
    s_movk_i32 s81, 3584
    s_mov_b32 s38, 1605632
    s_add_u32 s27, s49, 2
    s_cmp_lt_i32 s80, 0
    s_cselect_b32 s80, s27, s80
    s_cselect_b32 s81, 2688, s81
    s_cselect_b32 s36, s6, s12
    s_cselect_b32 s37, s7, s13
    s_cselect_b32 s38, 1204224, s38
    s_lshl_b32 s80, s80, 7
    v_mul_u32_u24 v13, s81, v13
    s_branch M_TD
M_T3:
    s_lshl_b32 s27, s52, 2
    s_and_b32 s80, s53, 3
    s_add_u32 s27, s27, s80
    s_mul_i32 s27, s27, 14
    v_min_u32 v13, 13, v1
    v_add_u32 v13, s27, v13
    v_mul_u32_u24 v13, 3584, v13
    s_mov_b32 s36, s12
    s_mov_b32 s37, s13
    s_mov_b32 s38, 1605632
    s_movk_i32 s80, 3456
M_TD:
    s_lshl_b32 s27, s57, 1
    s_add_u32 s27, s27, 23
    s_add_u32 s84, s51, 54
    s_cmp_eq_u32 s50, 7
    s_cselect_b32 s27, s84, s27
    s_mul_i32 s85, s58, 114
    s_add_u32 s85, s85, s27
    s_lshl_b32 s85, s85, 7
    s_add_u32 s85, s85, 14947584
    s_mul_i32 s84, s58, 147456
    s_lshl_b32 s27, s27, 11
    s_add_u32 s84, s84, s27
    s_add_u32 s84, s84, 5505024
    v_lshlrev_b32 v124, 2, v3
    v_sub_u32 v124, v2, v124
    v_mov_b32 v125, 0xffff
    v_mov_b32 v126, 0xffff0000
    v_cmp_le_i32 s[4:5], 0, v124
    v_cmp_le_i32 s[6:7], 1, v124
    v_cmp_le_i32 s[8:9], 2, v124
    v_cmp_le_i32 s[10:11], 3, v124
    v_cmp_le_i32 s[12:13], 8, v124
    v_cmp_le_i32 s[14:15], 9, v124
    v_cmp_le_i32 s[16:17], 10, v124
    v_cmp_le_i32 s[18:19], 11, v124
    v_cmp_le_i32 s[20:21], 16, v124
    v_cmp_le_i32 s[22:23], 17, v124
    v_cmp_le_i32 s[40:41], 18, v124
    v_cmp_le_i32 s[42:43], 19, v124
    v_cmp_le_i32 s[44:45], 24, v124
    v_cmp_le_i32 s[92:93], 25, v124
    v_cmp_le_i32 s[94:95], 26, v124
    v_cmp_le_i32 s[100:101], 27, v124
    v_cndmask_b32 v248, 0, v125, s[4:5]
    v_cndmask_b32 v127, 0, v126, s[6:7]
    v_or_b32 v248, v248, v127
    v_cndmask_b32 v249, 0, v125, s[8:9]
    v_cndmask_b32 v127, 0, v126, s[10:11]
    v_or_b32 v249, v249, v127
    v_cndmask_b32 v250, 0, v125, s[12:13]
    v_cndmask_b32 v127, 0, v126, s[14:15]
    v_or_b32 v250, v250, v127
    v_cndmask_b32 v251, 0, v125, s[16:17]
    v_cndmask_b32 v127, 0, v126, s[18:19]
    v_or_b32 v251, v251, v127
    v_cndmask_b32 v252, 0, v125, s[20:21]
    v_cndmask_b32 v127, 0, v126, s[22:23]
    v_or_b32 v252, v252, v127
    v_cndmask_b32 v253, 0, v125, s[40:41]
    v_cndmask_b32 v127, 0, v126, s[42:43]
    v_or_b32 v253, v253, v127
    v_cndmask_b32 v254, 0, v125, s[44:45]
    v_cndmask_b32 v127, 0, v126, s[92:93]
    v_or_b32 v254, v254, v127
    v_cndmask_b32 v255, 0, v125, s[94:95]
    v_cndmask_b32 v127, 0, v126, s[100:101]
    v_or_b32 v255, v255, v127
    s_lshl_b32 s27, s3, 12
    s_add_u32 s27, s27, s87
    v_add_u32 v124, s27, v59
    v_mul_u32_u24 v126, 448, v3
    v_lshl_add_u32 v125, v2, 4, v126
    v_add_u32 v126, 896, v125
    v_cmp_gt_u32 vcc, 28, v2
    v_mov_b32 v127, 1792
    s_add_u32 s27, s27, 2048
    v_cndmask_b32 v125, v127, v125, vcc
    v_cndmask_b32 v126, v127, v126, vcc
    v_add_u32 v125, s27, v125
    v_add_u32 v126, s27, v126
    s_waitcnt vmcnt(6)
    ds_read_b128 v[128:131], v8 offset:0
    ds_read_b128 v[132:135], v9 offset:0
    ds_read_b128 v[136:139], v10 offset:0
    ds_read_b128 v[140:143], v11 offset:0
    s_add_u32 m0, s60, 12288
    s_add_u32 s61, s59, 384
    buffer_load_dwordx4 v5, s[32:35], s61 offen offset:1024 lds
    buffer_load_dwordx4 v6, s[32:35], s61 offen offset:2048 lds
    buffer_load_dwordx4 v7, s[32:35], s61 offen offset:3072 lds
    s_waitcnt vmcnt(6)
    ds_read_b128 v[144:147], v8 offset:4096
    ds_read_b128 v[148:151], v9 offset:4096
    ds_read_b128 v[152:155], v10 offset:4096
    ds_read_b128 v[156:159], v11 offset:4096
    s_add_u32 m0, s60, 16384
    s_add_u32 s61, s59, 512
    buffer_load_dwordx4 v5, s[32:35], s61 offen offset:1024 lds
    buffer_load_dwordx4 v6, s[32:35], s61 offen offset:2048 lds
    buffer_load_dwordx4 v7, s[32:35], s61 offen offset:3072 lds
    s_waitcnt lgkmcnt(4)
    v_dot2c_f32_bf16 v14, s62, v128
    v_dot2c_f32_bf16 v15, v128, v128
    v_dot2c_f32_bf16 v14, s62, v129
    v_dot2c_f32_bf16 v15, v129, v129
    v_dot2c_f32_bf16 v14, s62, v130
    v_dot2c_f32_bf16 v15, v130, v130
    v_dot2c_f32_bf16 v14, s62, v131
    v_dot2c_f32_bf16 v15, v131, v131
    v_dot2c_f32_bf16 v14, s62, v132
    v_dot2c_f32_bf16 v15, v132, v132
    v_dot2c_f32_bf16 v14, s62, v133
    v_dot2c_f32_bf16 v15, v133, v133
    v_dot2c_f32_bf16 v14, s62, v134
    v_dot2c_f32_bf16 v15, v134, v134
    v_dot2c_f32_bf16 v14, s62, v135
    v_dot2c_f32_bf16 v15, v135, v135
    v_dot2c_f32_bf16 v14, s62, v136
    v_dot2c_f32_bf16 v15, v136, v136
    v_dot2c_f32_bf16 v14, s62, v137
    v_dot2c_f32_bf16 v15, v137, v137
    v_dot2c_f32_bf16 v14, s62, v138
    v_dot2c_f32_bf16 v15, v138, v138
    v_dot2c_f32_bf16 v14, s62, v139
    v_dot2c_f32_bf16 v15, v139, v139
    v_dot2c_f32_bf16 v14, s62, v140
    v_dot2c_f32_bf16 v15, v140, v140
    v_dot2c_f32_bf16 v14, s62, v141
    v_dot2c_f32_bf16 v15, v141, v141
    v_dot2c_f32_bf16 v14, s62, v142
    v_dot2c_f32_bf16 v15, v142, v142
    v_dot2c_f32_bf16 v14, s62, v143
    v_dot2c_f32_bf16 v15, v143, v143
    s_waitcnt vmcnt(6)
    ds_read_b128 v[160:163], v8 offset:8192
    ds_read_b128 v[164:167], v9 offset:8192
    ds_read_b128 v[168:171], v10 offset:8192
    ds_read_b128 v[172:175], v11 offset:8192
    s_add_u32 m0, s60, 20480
    s_add_u32 s61, s59, 640
    buffer_load_dwordx4 v5, s[32:35], s61 offen offset:1024 lds
    buffer_load_dwordx4 v6, s[32:35], s61 offen offset:2048 lds
    buffer_load_dwordx4 v7, s[32:35], s61 offen offset:3072 lds
    s_waitcnt lgkmcnt(4)
    v_dot2c_f32_bf16 v14, s62, v144
    v_dot2c_f32_bf16 v15, v144, v144
    v_dot2c_f32_bf16 v14, s62, v145
    v_dot2c_f32_bf16 v15, v145, v145
    v_dot2c_f32_bf16 v14, s62, v146
    v_dot2c_f32_bf16 v15, v146, v146
    v_dot2c_f32_bf16 v14, s62, v147
    v_dot2c_f32_bf16 v15, v147, v147
    v_dot2c_f32_bf16 v14, s62, v148
    v_dot2c_f32_bf16 v15, v148, v148
    v_dot2c_f32_bf16 v14, s62, v149
    v_dot2c_f32_bf16 v15, v149, v149
    v_dot2c_f32_bf16 v14, s62, v150
    v_dot2c_f32_bf16 v15, v150, v150
    v_dot2c_f32_bf16 v14, s62, v151
    v_dot2c_f32_bf16 v15, v151, v151
    v_dot2c_f32_bf16 v14, s62, v152
    v_dot2c_f32_bf16 v15, v152, v152
    v_dot2c_f32_bf16 v14, s62, v153
    v_dot2c_f32_bf16 v15, v153, v153
    v_dot2c_f32_bf16 v14, s62, v154
    v_dot2c_f32_bf16 v15, v154, v154
    v_dot2c_f32_bf16 v14, s62, v155
    v_dot2c_f32_bf16 v15, v155, v155
    v_dot2c_f32_bf16 v14, s62, v156
    v_dot2c_f32_bf16 v15, v156, v156
    v_dot2c_f32_bf16 v14, s62, v157
    v_dot2c_f32_bf16 v15, v157, v157
    v_dot2c_f32_bf16 v14, s62, v158
    v_dot2c_f32_bf16 v15, v158, v158
    v_dot2c_f32_bf16 v14, s62, v159
    v_dot2c_f32_bf16 v15, v159, v159
    s_waitcnt vmcnt(6)
    ds_read_b128 v[176:179], v8 offset:12288
    ds_read_b128 v[180:183], v9 offset:12288
    ds_read_b128 v[184:187], v10 offset:12288
    ds_read_b128 v[188:191], v11 offset:12288
    s_add_u32 m0, s60, 24576
    s_add_u32 s61, s59, 768
    buffer_load_dwordx4 v5, s[32:35], s61 offen offset:1024 lds
    buffer_load_dwordx4 v6, s[32:35], s61 offen offset:2048 lds
    buffer_load_dwordx4 v7, s[32:35], s61 offen offset:3072 lds
    s_waitcnt lgkmcnt(4)
    v_dot2c_f32_bf16 v14, s62, v160
    v_dot2c_f32_bf16 v15, v160, v160
    v_dot2c_f32_bf16 v14, s62, v161
    v_dot2c_f32_bf16 v15, v161, v161
    v_dot2c_f32_bf16 v14, s62, v162
    v_dot2c_f32_bf16 v15, v162, v162
    v_dot2c_f32_bf16 v14, s62, v163
    v_dot2c_f32_bf16 v15, v163, v163
    v_dot2c_f32_bf16 v14, s62, v164
    v_dot2c_f32_bf16 v15, v164, v164
    v_dot2c_f32_bf16 v14, s62, v165
    v_dot2c_f32_bf16 v15, v165, v165
    v_dot2c_f32_bf16 v14, s62, v166
    v_dot2c_f32_bf16 v15, v166, v166
    v_dot2c_f32_bf16 v14, s62, v167
    v_dot2c_f32_bf16 v15, v167, v167
    v_dot2c_f32_bf16 v14, s62, v168
    v_dot2c_f32_bf16 v15, v168, v168
    v_dot2c_f32_bf16 v14, s62, v169
    v_dot2c_f32_bf16 v15, v169, v169
    v_dot2c_f32_bf16 v14, s62, v170
    v_dot2c_f32_bf16 v15, v170, v170
    v_dot2c_f32_bf16 v14, s62, v171
    v_dot2c_f32_bf16 v15, v171, v171
    v_dot2c_f32_bf16 v14, s62, v172
    v_dot2c_f32_bf16 v15, v172, v172
    v_dot2c_f32_bf16 v14, s62, v173
    v_dot2c_f32_bf16 v15, v173, v173
    v_dot2c_f32_bf16 v14, s62, v174
    v_dot2c_f32_bf16 v15, v174, v174
    v_dot2c_f32_bf16 v14, s62, v175
    v_dot2c_f32_bf16 v15, v175, v175
    s_waitcnt vmcnt(6)
    ds_read_b128 v[192:195], v8 offset:16384
    ds_read_b128 v[196:199], v9 offset:16384
    ds_read_b128 v[200:203], v10 offset:16384
    ds_read_b128 v[204:207], v11 offset:16384
    s_waitcnt lgkmcnt(4)
    v_dot2c_f32_bf16 v14, s62, v176
    v_dot2c_f32_bf16 v15, v176, v176
    v_dot2c_f32_bf16 v14, s62, v177
    v_dot2c_f32_bf16 v15, v177, v177
    v_dot2c_f32_bf16 v14, s62, v178
    v_dot2c_f32_bf16 v15, v178, v178
    v_dot2c_f32_bf16 v14, s62, v179
    v_dot2c_f32_bf16 v15, v179, v179
    v_dot2c_f32_bf16 v14, s62, v180
    v_dot2c_f32_bf16 v15, v180, v180
    v_dot2c_f32_bf16 v14, s62, v181
    v_dot2c_f32_bf16 v15, v181, v181
    v_dot2c_f32_bf16 v14, s62, v182
    v_dot2c_f32_bf16 v15, v182, v182
    v_dot2c_f32_bf16 v14, s62, v183
    v_dot2c_f32_bf16 v15, v183, v183
    v_dot2c_f32_bf16 v14, s62, v184
    v_dot2c_f32_bf16 v15, v184, v184
    v_dot2c_f32_bf16 v14, s62, v185
    v_dot2c_f32_bf16 v15, v185, v185
    v_dot2c_f32_bf16 v14, s62, v186
    v_dot2c_f32_bf16 v15, v186, v186
    v_dot2c_f32_bf16 v14, s62, v187
    v_dot2c_f32_bf16 v15, v187, v187
    v_dot2c_f32_bf16 v14, s62, v188
    v_dot2c_f32_bf16 v15, v188, v188
    v_dot2c_f32_bf16 v14, s62, v189
    v_dot2c_f32_bf16 v15, v189, v189
    v_dot2c_f32_bf16 v14, s62, v190
    v_dot2c_f32_bf16 v15, v190, v190
    v_dot2c_f32_bf16 v14, s62, v191
    v_dot2c_f32_bf16 v15, v191, v191
    s_waitcnt vmcnt(3)
    ds_read_b128 v[208:211], v8 offset:20480
    ds_read_b128 v[212:215], v9 offset:20480
    ds_read_b128 v[216:219], v10 offset:20480
    ds_read_b128 v[220:223], v11 offset:20480
    s_waitcnt lgkmcnt(4)
    v_dot2c_f32_bf16 v14, s62, v192
    v_dot2c_f32_bf16 v15, v192, v192
    v_dot2c_f32_bf16 v14, s62, v193
    v_dot2c_f32_bf16 v15, v193, v193
    v_dot2c_f32_bf16 v14, s62, v194
    v_dot2c_f32_bf16 v15, v194, v194
    v_dot2c_f32_bf16 v14, s62, v195
    v_dot2c_f32_bf16 v15, v195, v195
    v_dot2c_f32_bf16 v14, s62, v196
    v_dot2c_f32_bf16 v15, v196, v196
    v_dot2c_f32_bf16 v14, s62, v197
    v_dot2c_f32_bf16 v15, v197, v197
    v_dot2c_f32_bf16 v14, s62, v198
    v_dot2c_f32_bf16 v15, v198, v198
    v_dot2c_f32_bf16 v14, s62, v199
    v_dot2c_f32_bf16 v15, v199, v199
    v_dot2c_f32_bf16 v14, s62, v200
    v_dot2c_f32_bf16 v15, v200, v200
    v_dot2c_f32_bf16 v14, s62, v201
    v_dot2c_f32_bf16 v15, v201, v201
    v_dot2c_f32_bf16 v14, s62, v202
    v_dot2c_f32_bf16 v15, v202, v202
    v_dot2c_f32_bf16 v14, s62, v203
    v_dot2c_f32_bf16 v15, v203, v203
    v_dot2c_f32_bf16 v14, s62, v204
    v_dot2c_f32_bf16 v15, v204, v204
    v_dot2c_f32_bf16 v14, s62, v205
    v_dot2c_f32_bf16 v15, v205, v205
    v_dot2c_f32_bf16 v14, s62, v206
    v_dot2c_f32_bf16 v15, v206, v206
    v_dot2c_f32_bf16 v14, s62, v207
    v_dot2c_f32_bf16 v15, v207, v207
    s_waitcnt vmcnt(0)
    ds_read_b128 v[224:227], v8 offset:24576
    ds_read_b128 v[228:231], v9 offset:24576
    ds_read_b128 v[232:235], v10 offset:24576
    ds_read_b128 v[236:239], v11 offset:24576
    s_waitcnt lgkmcnt(4)
    v_dot2c_f32_bf16 v14, s62, v208
    v_dot2c_f32_bf16 v15, v208, v208
    v_dot2c_f32_bf16 v14, s62, v209
    v_dot2c_f32_bf16 v15, v209, v209
    v_dot2c_f32_bf16 v14, s62, v210
    v_dot2c_f32_bf16 v15, v210, v210
    v_dot2c_f32_bf16 v14, s62, v211
    v_dot2c_f32_bf16 v15, v211, v211
    v_dot2c_f32_bf16 v14, s62, v212
    v_dot2c_f32_bf16 v15, v212, v212
    v_dot2c_f32_bf16 v14, s62, v213
    v_dot2c_f32_bf16 v15, v213, v213
    v_dot2c_f32_bf16 v14, s62, v214
    v_dot2c_f32_bf16 v15, v214, v214
    v_dot2c_f32_bf16 v14, s62, v215
    v_dot2c_f32_bf16 v15, v215, v215
    v_dot2c_f32_bf16 v14, s62, v216
    v_dot2c_f32_bf16 v15, v216, v216
    v_dot2c_f32_bf16 v14, s62, v217
    v_dot2c_f32_bf16 v15, v217, v217
    v_dot2c_f32_bf16 v14, s62, v218
    v_dot2c_f32_bf16 v15, v218, v218
    v_dot2c_f32_bf16 v14, s62, v219
    v_dot2c_f32_bf16 v15, v219, v219
    v_dot2c_f32_bf16 v14, s62, v220
    v_dot2c_f32_bf16 v15, v220, v220
    v_dot2c_f32_bf16 v14, s62, v221
    v_dot2c_f32_bf16 v15, v221, v221
    v_dot2c_f32_bf16 v14, s62, v222
    v_dot2c_f32_bf16 v15, v222, v222
    v_dot2c_f32_bf16 v14, s62, v223
    v_dot2c_f32_bf16 v15, v223, v223
    s_waitcnt lgkmcnt(0)
    s_barrier
    v_dot2c_f32_bf16 v14, s62, v224
    v_dot2c_f32_bf16 v15, v224, v224
    v_dot2c_f32_bf16 v14, s62, v225
    v_dot2c_f32_bf16 v15, v225, v225
    v_dot2c_f32_bf16 v14, s62, v226
    v_dot2c_f32_bf16 v15, v226, v226
    v_dot2c_f32_bf16 v14, s62, v227
    v_dot2c_f32_bf16 v15, v227, v227
    v_dot2c_f32_bf16 v14, s62, v228
    v_dot2c_f32_bf16 v15, v228, v228
    v_dot2c_f32_bf16 v14, s62, v229
    v_dot2c_f32_bf16 v15, v229, v229
    v_dot2c_f32_bf16 v14, s62, v230
    v_dot2c_f32_bf16 v15, v230, v230
    v_dot2c_f32_bf16 v14, s62, v231
    v_dot2c_f32_bf16 v15, v231, v231
    v_dot2c_f32_bf16 v14, s62, v232
    v_dot2c_f32_bf16 v15, v232, v232
    v_dot2c_f32_bf16 v14, s62, v233
    v_dot2c_f32_bf16 v15, v233, v233
    v_dot2c_f32_bf16 v14, s62, v234
    v_dot2c_f32_bf16 v15, v234, v234
    v_dot2c_f32_bf16 v14, s62, v235
    v_dot2c_f32_bf16 v15, v235, v235
    v_dot2c_f32_bf16 v14, s62, v236
    v_dot2c_f32_bf16 v15, v236, v236
    v_dot2c_f32_bf16 v14, s62, v237
    v_dot2c_f32_bf16 v15, v237, v237
    v_dot2c_f32_bf16 v14, s62, v238
    v_dot2c_f32_bf16 v15, v238, v238
    v_dot2c_f32_bf16 v14, s62, v239
    v_dot2c_f32_bf16 v15, v239, v239
    s_nop 2
    v_mov_b32 v4, v14
    v_mov_b32 v5, v15
    s_nop 1
    v_permlane32_swap_b32 v4, v14
    v_permlane32_swap_b32 v5, v15
    v_add_f32 v14, v4, v14
    v_add_f32 v15, v5, v15
    v_mul_f32 v14, 0x3b124925, v14
    v_mul_f32 v15, 0x3b124925, v15
    v_cvt_pk_bf16_f32 v4, v14, v14
    v_fma_f32 v15, -v14, v14, v15
    v_lshlrev_b32 v4, 16, v4
    v_max_f32 v15, 0, v15
    v_xor_b32 v4, 0x80000000, v4
    v_mov_b32 v16, v4
    v_mov_b32 v17, v4
    v_mov_b32 v18, v4
    v_mov_b32 v19, v4
    v_mov_b32 v20, v4
    v_mov_b32 v21, v4
    v_mov_b32 v22, v4
    v_mov_b32 v23, v4
    v_mov_b32 v24, v4
    v_mov_b32 v25, v4
    v_mov_b32 v26, v4
    v_mov_b32 v27, v4
    v_mov_b32 v28, v4
    v_mov_b32 v29, v4
    v_mov_b32 v30, v4
    v_mov_b32 v31, v4
    s_nop 1
    v_mfma_f32_32x32x16_bf16 v[64:79], v[96:99], v[128:131], v[16:31]
    v_cvt_pk_bf16_f32 v15, v15, v15
    v_lshlrev_b32 v15, 16, v15
    v_add_f32 v15, 0x3727c5ac, v15
    v_cvt_pk_bf16_f32 v15, v15, v15
    v_lshlrev_b32 v15, 16, v15
    v_sqrt_f32 v15, v15
    s_lshl_b32 s27, s3, 8
    v_mfma_f32_32x32x16_bf16 v[64:79], v[100:103], v[132:135], v[64:79]
    v_cvt_pk_bf16_f32 v5, v15, v15
    v_lshlrev_b32 v15, 16, v5
    v_rcp_f32 v14, v15
    v_and_b32 v5, 0xffff, v5
    v_cmp_eq_u32 vcc, 0, v3
    s_add_u32 s27, s27, 160512
    v_lshl_add_u32 v4, v1, 2, s27
    v_mfma_f32_32x32x16_bf16 v[80:95], v[96:99], v[136:139], v[16:31]
    v_cndmask_b32 v6, v15, v14, vcc
    v_cndmask_b32 v244, 0, v5, vcc
    ds_write_b32 v4, v6
    v_mov_b32 v241, 0
    v_mov_b32 v242, 0
    v_mov_b32 v243, 0
    v_mov_b32 v245, 0
    v_mfma_f32_32x32x16_bf16 v[80:95], v[100:103], v[140:143], v[80:95]
    v_mov_b32 v246, 0
    v_mov_b32 v247, 0
    v_lshlrev_b32 v10, 1, v2
    v_add_u32 v10, 159744, v10
    s_lshl_b32 s83, s3, 13
    v_add_u32 v8, 86016, v12
    s_mov_b32 s68, 0
    v_mfma_f32_32x32x16_bf16 v[32:47], v[96:99], v[144:147], v[16:31]
    v_cvt_pk_bf16_f32 v128, v64, v65
    v_cvt_pk_bf16_f32 v129, v66, v67
    v_cvt_pk_bf16_f32 v130, v68, v69
    v_cvt_pk_bf16_f32 v131, v70, v71
    v_mfma_f32_32x32x16_bf16 v[32:47], v[100:103], v[148:151], v[32:47]
    v_cvt_pk_bf16_f32 v132, v72, v73
    v_cvt_pk_bf16_f32 v133, v74, v75
    v_cvt_pk_bf16_f32 v134, v76, v77
    v_cvt_pk_bf16_f32 v135, v78, v79
    s_mov_b32 s64, 2818637993
    v_mfma_f32_32x32x16_bf16 v[64:79], v[96:99], v[152:155], v[16:31]
    v_cvt_pk_bf16_f32 v136, v80, v81
    v_cvt_pk_bf16_f32 v137, v82, v83
    v_cvt_pk_bf16_f32 v138, v84, v85
    v_cvt_pk_bf16_f32 v139, v86, v87
    v_mfma_f32_32x32x16_bf16 v[64:79], v[100:103], v[156:159], v[64:79]
    v_cvt_pk_bf16_f32 v140, v88, v89
    v_cvt_pk_bf16_f32 v141, v90, v91
    v_cvt_pk_bf16_f32 v142, v92, v93
    v_cvt_pk_bf16_f32 v143, v94, v95
    s_mov_b32 s65, 169
    v_mfma_f32_32x32x16_bf16 v[80:95], v[96:99], v[160:163], v[16:31]
    v_cvt_pk_bf16_f32 v144, v32, v33
    v_cvt_pk_bf16_f32 v145, v34, v35
    v_cvt_pk_bf16_f32 v146, v36, v37
    v_cvt_pk_bf16_f32 v147, v38, v39
    v_mfma_f32_32x32x16_bf16 v[80:95], v[100:103], v[164:167], v[80:95]
    v_cvt_pk_bf16_f32 v148, v40, v41
    v_cvt_pk_bf16_f32 v149, v42, v43
    v_cvt_pk_bf16_f32 v150, v44, v45
    v_cvt_pk_bf16_f32 v151, v46, v47
    s_mov_b32 s66, 960000368
    v_mfma_f32_32x32x16_bf16 v[32:47], v[96:99], v[168:171], v[16:31]
    v_cvt_pk_bf16_f32 v152, v64, v65
    v_cvt_pk_bf16_f32 v153, v66, v67
    v_cvt_pk_bf16_f32 v154, v68, v69
    v_cvt_pk_bf16_f32 v155, v70, v71
    v_mfma_f32_32x32x16_bf16 v[32:47], v[100:103], v[172:175], v[32:47]
    v_cvt_pk_bf16_f32 v156, v72, v73
    v_cvt_pk_bf16_f32 v157, v74, v75
    v_cvt_pk_bf16_f32 v158, v76, v77
    v_cvt_pk_bf16_f32 v159, v78, v79
    s_mov_b32 s67, 94576
    v_mfma_f32_32x32x16_bf16 v[64:79], v[96:99], v[176:179], v[16:31]
    v_cvt_pk_bf16_f32 v160, v80, v81
    v_cvt_pk_bf16_f32 v161, v82, v83
    v_cvt_pk_bf16_f32 v162, v84, v85
    v_cvt_pk_bf16_f32 v163, v86, v87
    v_mfma_f32_32x32x16_bf16 v[64:79], v[100:103], v[180:183], v[64:79]
    v_cvt_pk_bf16_f32 v164, v88, v89
    v_cvt_pk_bf16_f32 v165, v90, v91
    v_cvt_pk_bf16_f32 v166, v92, v93
    v_cvt_pk_bf16_f32 v167, v94, v95
    s_mov_b32 s69, s54
    v_mfma_f32_32x32x16_bf16 v[80:95], v[96:99], v[184:187], v[16:31]
    v_cvt_pk_bf16_f32 v168, v32, v33
    v_cvt_pk_bf16_f32 v169, v34, v35
    v_cvt_pk_bf16_f32 v170, v36, v37
    v_cvt_pk_bf16_f32 v171, v38, v39
    v_mfma_f32_32x32x16_bf16 v[80:95], v[100:103], v[188:191], v[80:95]
    v_cvt_pk_bf16_f32 v172, v40, v41
    v_cvt_pk_bf16_f32 v173, v42, v43
    v_cvt_pk_bf16_f32 v174, v44, v45
    v_cvt_pk_bf16_f32 v175, v46, v47
    v_mul_f32 v7, 0xc0135761, v14
    v_mfma_f32_32x32x16_bf16 v[32:47], v[96:99], v[192:195], v[16:31]
    v_cvt_pk_bf16_f32 v176, v64, v65
    v_cvt_pk_bf16_f32 v177, v66, v67
    v_cvt_pk_bf16_f32 v178, v68, v69
    v_cvt_pk_bf16_f32 v179, v70, v71
    v_mfma_f32_32x32x16_bf16 v[32:47], v[100:103], v[196:199], v[32:47]
    v_cvt_pk_bf16_f32 v180, v72, v73
    v_cvt_pk_bf16_f32 v181, v74, v75
    v_cvt_pk_bf16_f32 v182, v76, v77
    v_cvt_pk_bf16_f32 v183, v78, v79
    v_mul_f32 v6, v14, v14
    v_mfma_f32_32x32x16_bf16 v[64:79], v[96:99], v[200:203], v[16:31]
    v_cvt_pk_bf16_f32 v184, v80, v81
    v_cvt_pk_bf16_f32 v185, v82, v83
    v_cvt_pk_bf16_f32 v186, v84, v85
    v_cvt_pk_bf16_f32 v187, v86, v87
    v_mfma_f32_32x32x16_bf16 v[64:79], v[100:103], v[204:207], v[64:79]
    v_cvt_pk_bf16_f32 v188, v88, v89
    v_cvt_pk_bf16_f32 v189, v90, v91
    v_cvt_pk_bf16_f32 v190, v92, v93
    v_cvt_pk_bf16_f32 v191, v94, v95
    v_mul_f32 v6, v6, v14
    v_mfma_f32_32x32x16_bf16 v[80:95], v[96:99], v[208:211], v[16:31]
    v_cvt_pk_bf16_f32 v192, v32, v33
    v_cvt_pk_bf16_f32 v193, v34, v35
    v_cvt_pk_bf16_f32 v194, v36, v37
    v_cvt_pk_bf16_f32 v195, v38, v39
    v_mfma_f32_32x32x16_bf16 v[80:95], v[100:103], v[212:215], v[80:95]
    v_cvt_pk_bf16_f32 v196, v40, v41
    v_cvt_pk_bf16_f32 v197, v42, v43
    v_cvt_pk_bf16_f32 v198, v44, v45
    v_cvt_pk_bf16_f32 v199, v46, v47
    v_mul_f32 v6, 0xbdd2d3e8, v6
    v_mfma_f32_32x32x16_bf16 v[32:47], v[96:99], v[216:219], v[16:31]
    v_cvt_pk_bf16_f32 v200, v64, v65
    v_cvt_pk_bf16_f32 v201, v66, v67
    v_cvt_pk_bf16_f32 v202, v68, v69
    v_cvt_pk_bf16_f32 v203, v70, v71
    v_mfma_f32_32x32x16_bf16 v[32:47], v[100:103], v[220:223], v[32:47]
    v_cvt_pk_bf16_f32 v204, v72, v73
    v_cvt_pk_bf16_f32 v205, v74, v75
    v_cvt_pk_bf16_f32 v206, v76, v77
    v_cvt_pk_bf16_f32 v207, v78, v79
    v_mfma_f32_32x32x16_bf16 v[64:79], v[96:99], v[224:227], v[16:31]
    v_cvt_pk_bf16_f32 v208, v80, v81
    v_cvt_pk_bf16_f32 v209, v82, v83
    v_cvt_pk_bf16_f32 v210, v84, v85
    v_cvt_pk_bf16_f32 v211, v86, v87
    v_mfma_f32_32x32x16_bf16 v[64:79], v[100:103], v[228:231], v[64:79]
    v_cvt_pk_bf16_f32 v212, v88, v89
    v_cvt_pk_bf16_f32 v213, v90, v91
    v_cvt_pk_bf16_f32 v214, v92, v93
    v_cvt_pk_bf16_f32 v215, v94, v95
    v_mfma_f32_32x32x16_bf16 v[80:95], v[96:99], v[232:235], v[16:31]
    v_cvt_pk_bf16_f32 v216, v32, v33
    v_cvt_pk_bf16_f32 v217, v34, v35
    v_cvt_pk_bf16_f32 v218, v36, v37
    v_cvt_pk_bf16_f32 v219, v38, v39
    v_mfma_f32_32x32x16_bf16 v[80:95], v[100:103], v[236:239], v[80:95]
    v_cvt_pk_bf16_f32 v220, v40, v41
    v_cvt_pk_bf16_f32 v221, v42, v43
    v_cvt_pk_bf16_f32 v222, v44, v45
    v_cvt_pk_bf16_f32 v223, v46, v47
    v_cvt_pk_bf16_f32 v224, v64, v65
    v_cvt_pk_bf16_f32 v225, v66, v67
    v_cvt_pk_bf16_f32 v226, v68, v69
    v_cvt_pk_bf16_f32 v227, v70, v71
    v_cvt_pk_bf16_f32 v228, v72, v73
    v_cvt_pk_bf16_f32 v229, v74, v75
    v_cvt_pk_bf16_f32 v230, v76, v77
    v_cvt_pk_bf16_f32 v231, v78, v79
    s_nop 1
    v_cvt_pk_bf16_f32 v232, v80, v81
    v_cvt_pk_bf16_f32 v233, v82, v83
    v_cvt_pk_bf16_f32 v234, v84, v85
    v_cvt_pk_bf16_f32 v235, v86, v87
    v_cvt_pk_bf16_f32 v236, v88, v89
    v_cvt_pk_bf16_f32 v237, v90, v91
    v_cvt_pk_bf16_f32 v238, v92, v93
    v_cvt_pk_bf16_f32 v239, v94, v95
    s_cmp_eq_u32 s3, 0
    s_cselect_b32 s81, 1, s86
    s_cbranch_scc1 M_NOT
    buffer_load_dword v60, v13, s[36:39], s80 offen
M_NOT:
    s_waitcnt lgkmcnt(0)
    s_barrier
    ds_read_b64_tr_b16 v[96:97], v8 offset:0
    ds_read_b64_tr_b16 v[98:99], v8 offset:256
    ds_read_b64_tr_b16 v[100:101], v8 offset:2048
    ds_read_b64_tr_b16 v[102:103], v8 offset:2304
    ds_read_b64_tr_b16 v[104:105], v8 offset:4096
    ds_read_b64_tr_b16 v[106:107], v8 offset:4352
    ds_read_b64_tr_b16 v[108:109], v8 offset:6144
    ds_read_b64_tr_b16 v[110:111], v8 offset:6400
M_TILE:
    s_cmp_eq_u32 s68, s81
    s_cbranch_scc1 M_SIDE
M_SIDER:
    s_mov_b32 m0, s83
    s_bitcmp1_b32 s69, 0
    s_cbranch_scc1 M_V
    s_waitcnt lgkmcnt(4)
    s_bitcmp1_b32 s69, 1
    s_cbranch_scc0 M_NOB
    v_mfma_f32_32x32x16_bf16 v[64:79], v[240:243], v[244:247], 0
    v_mfma_f32_32x32x16_bf16 v[64:79], v[96:99], v[128:131], v[64:79]
    s_branch M_NOB2
M_NOB:
    v_mfma_f32_32x32x16_bf16 v[64:79], v[96:99], v[128:131], 0
M_NOB2:
    ds_read_b64_tr_b16 v[112:113], v8 offset:8192
    ds_read_b64_tr_b16 v[114:115], v8 offset:8448
    s_and_b32 s27, s66, 0xff
    s_lshr_b64 s[66:67], s[66:67], 8
    v_lshl_add_u32 v9, s27, 9, v12
    v_add_u32 v10, 64, v10
    v_mfma_f32_32x32x16_bf16 v[64:79], v[100:103], v[132:135], v[64:79]
    ds_write_addtid_b32 v80 offset:0
    ds_write_addtid_b32 v81 offset:256
    ds_write_addtid_b32 v82 offset:512
    ds_read_b64_tr_b16 v[116:117], v8 offset:10240
    ds_read_b64_tr_b16 v[118:119], v8 offset:10496
    s_waitcnt lgkmcnt(7)
    v_mfma_f32_32x32x16_bf16 v[64:79], v[104:107], v[136:139], v[64:79]
    ds_write_addtid_b32 v83 offset:768
    ds_write_addtid_b32 v84 offset:1024
    ds_write_addtid_b32 v85 offset:1280
    ds_read_b64_tr_b16 v[120:121], v8 offset:12288
    ds_read_b64_tr_b16 v[122:123], v8 offset:12544
    v_mfma_f32_32x32x16_bf16 v[64:79], v[108:111], v[140:143], v[64:79]
    ds_write_addtid_b32 v86 offset:1536
    ds_write_addtid_b32 v87 offset:1792
    ds_write_addtid_b32 v88 offset:2048
    ds_read_b64_tr_b16 v[96:97], v8 offset:14336
    ds_read_b64_tr_b16 v[98:99], v8 offset:14592
    s_waitcnt lgkmcnt(10)
    v_mfma_f32_32x32x16_bf16 v[64:79], v[112:115], v[144:147], v[64:79]
    ds_write_addtid_b32 v89 offset:2304
    ds_write_addtid_b32 v90 offset:2560
    ds_write_addtid_b32 v91 offset:2816
    ds_read_b64_tr_b16 v[100:101], v8 offset:16384
    ds_read_b64_tr_b16 v[102:103], v8 offset:16640
    v_mfma_f32_32x32x16_bf16 v[64:79], v[116:119], v[148:151], v[64:79]
    ds_write_addtid_b32 v92 offset:3072
    ds_write_addtid_b32 v93 offset:3328
    ds_read_b64_tr_b16 v[104:105], v8 offset:18432
    ds_read_b64_tr_b16 v[106:107], v8 offset:18688
    s_waitcnt lgkmcnt(9)
    v_mfma_f32_32x32x16_bf16 v[64:79], v[120:123], v[152:155], v[64:79]
    ds_write_addtid_b32 v94 offset:3584
    ds_write_addtid_b32 v95 offset:3840
    ds_read_b64_tr_b16 v[108:109], v8 offset:20480
    ds_read_b64_tr_b16 v[110:111], v8 offset:20736
    v_mfma_f32_32x32x16_bf16 v[64:79], v[96:99], v[156:159], v[64:79]
    ds_read_b64_tr_b16 v[112:113], v8 offset:22528
    ds_read_b64_tr_b16 v[114:115], v8 offset:22784
    s_waitcnt lgkmcnt(6)
    v_mfma_f32_32x32x16_bf16 v[64:79], v[100:103], v[160:163], v[64:79]
    ds_read_b64_tr_b16 v[116:117], v8 offset:24576
    ds_read_b64_tr_b16 v[118:119], v8 offset:24832
    v_mfma_f32_32x32x16_bf16 v[64:79], v[104:107], v[164:167], v[64:79]
    ds_read_b64_tr_b16 v[120:121], v8 offset:26624
    ds_read_b64_tr_b16 v[122:123], v8 offset:26880
    s_waitcnt lgkmcnt(4)
    v_mfma_f32_32x32x16_bf16 v[64:79], v[108:111], v[168:171], v[64:79]
    s_barrier
    ds_read_b64_tr_b16 v[96:97], v9 offset:0
    ds_read_b64_tr_b16 v[98:99], v9 offset:256
    v_mfma_f32_32x32x16_bf16 v[64:79], v[112:115], v[172:175], v[64:79]
    ds_read_b64_tr_b16 v[100:101], v9 offset:2048
    ds_read_b64_tr_b16 v[102:103], v9 offset:2304
    s_waitcnt lgkmcnt(4)
    v_mfma_f32_32x32x16_bf16 v[64:79], v[116:119], v[176:179], v[64:79]
    ds_read_b64_tr_b16 v[104:105], v9 offset:4096
    ds_read_b64_tr_b16 v[106:107], v9 offset:4352
    s_and_b32 s27, s64, 0xff
    s_lshr_b64 s[64:65], s[64:65], 8
    v_lshl_add_u32 v8, s27, 9, v12
    s_xor_b32 s83, s83, 4096
    v_mfma_f32_32x32x16_bf16 v[64:79], v[120:123], v[180:183], v[64:79]
    ds_read_b64_tr_b16 v[108:109], v9 offset:6144
    ds_read_b64_tr_b16 v[110:111], v9 offset:6400
    s_waitcnt lgkmcnt(4)
    v_mfma_f32_32x32x16_bf16 v[64:79], v[96:99], v[184:187], v[64:79]
    ds_read_b64_tr_b16 v[112:113], v9 offset:8192
    ds_read_b64_tr_b16 v[114:115], v9 offset:8448
    v_mfma_f32_32x32x16_bf16 v[64:79], v[100:103], v[188:191], v[64:79]
    ds_read_b64_tr_b16 v[116:117], v9 offset:10240
    ds_read_b64_tr_b16 v[118:119], v9 offset:10496
    s_waitcnt lgkmcnt(4)
    v_mfma_f32_32x32x16_bf16 v[64:79], v[104:107], v[192:195], v[64:79]
    ds_read_b64_tr_b16 v[120:121], v9 offset:12288
    ds_read_b64_tr_b16 v[122:123], v9 offset:12544
    v_mfma_f32_32x32x16_bf16 v[64:79], v[108:111], v[196:199], v[64:79]
    ds_read_b64_tr_b16 v[96:97], v9 offset:14336
    ds_read_b64_tr_b16 v[98:99], v9 offset:14592
    s_waitcnt lgkmcnt(4)
    v_mfma_f32_32x32x16_bf16 v[64:79], v[112:115], v[200:203], v[64:79]
    ds_read_b64_tr_b16 v[100:101], v9 offset:16384
    ds_read_b64_tr_b16 v[102:103], v9 offset:16640
    v_mfma_f32_32x32x16_bf16 v[64:79], v[116:119], v[204:207], v[64:79]
    ds_read_b64_tr_b16 v[104:105], v9 offset:18432
    ds_read_b64_tr_b16 v[106:107], v9 offset:18688
    s_waitcnt lgkmcnt(4)
    v_mfma_f32_32x32x16_bf16 v[64:79], v[120:123], v[208:211], v[64:79]
    ds_read_b64_tr_b16 v[108:109], v9 offset:20480
    ds_read_b64_tr_b16 v[110:111], v9 offset:20736
    v_mfma_f32_32x32x16_bf16 v[64:79], v[96:99], v[212:215], v[64:79]
    ds_read_b64_tr_b16 v[112:113], v9 offset:22528
    ds_read_b64_tr_b16 v[114:115], v9 offset:22784
    s_waitcnt lgkmcnt(4)
    v_mfma_f32_32x32x16_bf16 v[64:79], v[100:103], v[216:219], v[64:79]
    ds_read_b64_tr_b16 v[116:117], v9 offset:24576
    ds_read_b64_tr_b16 v[118:119], v9 offset:24832
    v_mfma_f32_32x32x16_bf16 v[64:79], v[104:107], v[220:223], v[64:79]
    ds_read_b64_tr_b16 v[120:121], v9 offset:26624
    ds_read_b64_tr_b16 v[122:123], v9 offset:26880
    ds_read_u16 v240, v10
    s_waitcnt lgkmcnt(5)
    v_mfma_f32_32x32x16_bf16 v[64:79], v[108:111], v[224:227], v[64:79]
    ds_read_b64_tr_b16 v[96:97], v8 offset:0
    ds_read_b64_tr_b16 v[98:99], v8 offset:256
    v_mfma_f32_32x32x16_bf16 v[64:79], v[112:115], v[228:231], v[64:79]
    ds_read_b64_tr_b16 v[100:101], v8 offset:2048
    ds_read_b64_tr_b16 v[102:103], v8 offset:2304
    s_waitcnt lgkmcnt(5)
    v_mfma_f32_32x32x16_bf16 v[64:79], v[116:119], v[232:235], v[64:79]
    ds_read_b64_tr_b16 v[104:105], v8 offset:4096
    ds_read_b64_tr_b16 v[106:107], v8 offset:4352
    v_mfma_f32_32x32x16_bf16 v[80:95], v[120:123], v[236:239], v[64:79]
    ds_read_b64_tr_b16 v[108:109], v8 offset:6144
    ds_read_b64_tr_b16 v[110:111], v8 offset:6400
    s_lshr_b32 s69, s69, 2
    s_add_u32 s68, s68, 1
    s_cmp_lt_u32 s68, s50
    s_cbranch_scc1 M_TILE
    s_branch M_DONE
M_SIDE:
    s_cmp_eq_u32 s68, s86
    s_cbranch_scc1 M_SIDE2
    buffer_load_dword v60, v13, s[36:39], s80 offen
    s_mov_b32 s81, s86
    s_branch M_SIDER
M_SIDE2:
    v_mov_b32 v61, 161600
    ds_read_b32 v61, v61
    s_mov_b64 exec, 0xffff
    buffer_load_dword v60, v56, s[28:31], 0 offen sc1
    s_mov_b64 exec, -1
    s_branch M_SIDER
M_V:
    s_waitcnt lgkmcnt(4)
    v_mfma_f32_32x32x16_bf16 v[64:79], v[128:131], v[96:99], 0
    ds_read_b64_tr_b16 v[112:113], v8 offset:8192
    ds_read_b64_tr_b16 v[114:115], v8 offset:8448
    s_and_b32 s27, s66, 0xff
    s_lshr_b64 s[66:67], s[66:67], 8
    v_lshl_add_u32 v9, s27, 9, v12
    v_add_u32 v10, 64, v10
    v_mfma_f32_32x32x16_bf16 v[64:79], v[132:135], v[100:103], v[64:79]
    ds_write_addtid_b32 v80 offset:0
    ds_write_addtid_b32 v81 offset:256
    ds_write_addtid_b32 v82 offset:512
    ds_read_b64_tr_b16 v[116:117], v8 offset:10240
    ds_read_b64_tr_b16 v[118:119], v8 offset:10496
    s_waitcnt lgkmcnt(7)
    v_mfma_f32_32x32x16_bf16 v[64:79], v[136:139], v[104:107], v[64:79]
    ds_write_addtid_b32 v83 offset:768
    ds_write_addtid_b32 v84 offset:1024
    ds_write_addtid_b32 v85 offset:1280
    ds_read_b64_tr_b16 v[120:121], v8 offset:12288
    ds_read_b64_tr_b16 v[122:123], v8 offset:12544
    v_mfma_f32_32x32x16_bf16 v[64:79], v[140:143], v[108:111], v[64:79]
    ds_write_addtid_b32 v86 offset:1536
    ds_write_addtid_b32 v87 offset:1792
    ds_write_addtid_b32 v88 offset:2048
    ds_read_b64_tr_b16 v[96:97], v8 offset:14336
    ds_read_b64_tr_b16 v[98:99], v8 offset:14592
    s_waitcnt lgkmcnt(10)
    v_mfma_f32_32x32x16_bf16 v[64:79], v[144:147], v[112:115], v[64:79]
    ds_write_addtid_b32 v89 offset:2304
    ds_write_addtid_b32 v90 offset:2560
    ds_write_addtid_b32 v91 offset:2816
    ds_read_b64_tr_b16 v[100:101], v8 offset:16384
    ds_read_b64_tr_b16 v[102:103], v8 offset:16640
    v_mfma_f32_32x32x16_bf16 v[64:79], v[148:151], v[116:119], v[64:79]
    ds_write_addtid_b32 v92 offset:3072
    ds_write_addtid_b32 v93 offset:3328
    ds_read_b64_tr_b16 v[104:105], v8 offset:18432
    ds_read_b64_tr_b16 v[106:107], v8 offset:18688
    s_waitcnt lgkmcnt(9)
    v_mfma_f32_32x32x16_bf16 v[64:79], v[152:155], v[120:123], v[64:79]
    ds_write_addtid_b32 v94 offset:3584
    ds_write_addtid_b32 v95 offset:3840
    ds_read_b64_tr_b16 v[108:109], v8 offset:20480
    ds_read_b64_tr_b16 v[110:111], v8 offset:20736
    v_mfma_f32_32x32x16_bf16 v[64:79], v[156:159], v[96:99], v[64:79]
    ds_read_b64_tr_b16 v[112:113], v8 offset:22528
    ds_read_b64_tr_b16 v[114:115], v8 offset:22784
    s_waitcnt lgkmcnt(6)
    v_mfma_f32_32x32x16_bf16 v[64:79], v[160:163], v[100:103], v[64:79]
    ds_read_b64_tr_b16 v[116:117], v8 offset:24576
    ds_read_b64_tr_b16 v[118:119], v8 offset:24832
    v_mfma_f32_32x32x16_bf16 v[64:79], v[164:167], v[104:107], v[64:79]
    ds_read_b64_tr_b16 v[120:121], v8 offset:26624
    ds_read_b64_tr_b16 v[122:123], v8 offset:26880
    s_waitcnt lgkmcnt(4)
    v_mfma_f32_32x32x16_bf16 v[64:79], v[168:171], v[108:111], v[64:79]
    s_barrier
    ds_read_b64_tr_b16 v[96:97], v9 offset:0
    ds_read_b64_tr_b16 v[98:99], v9 offset:256
    v_mfma_f32_32x32x16_bf16 v[64:79], v[172:175], v[112:115], v[64:79]
    ds_read_b64_tr_b16 v[100:101], v9 offset:2048
    ds_read_b64_tr_b16 v[102:103], v9 offset:2304
    s_waitcnt lgkmcnt(4)
    v_mfma_f32_32x32x16_bf16 v[64:79], v[176:179], v[116:119], v[64:79]
    ds_read_b64_tr_b16 v[104:105], v9 offset:4096
    ds_read_b64_tr_b16 v[106:107], v9 offset:4352
    s_and_b32 s27, s64, 0xff
    s_lshr_b64 s[64:65], s[64:65], 8
    v_lshl_add_u32 v8, s27, 9, v12
    s_xor_b32 s83, s83, 4096
    v_mfma_f32_32x32x16_bf16 v[64:79], v[180:183], v[120:123], v[64:79]
    ds_read_b64_tr_b16 v[108:109], v9 offset:6144
    ds_read_b64_tr_b16 v[110:111], v9 offset:6400
    s_waitcnt lgkmcnt(4)
    v_mfma_f32_32x32x16_bf16 v[64:79], v[184:187], v[96:99], v[64:79]
    ds_read_b64_tr_b16 v[112:113], v9 offset:8192
    ds_read_b64_tr_b16 v[114:115], v9 offset:8448
    v_mfma_f32_32x32x16_bf16 v[64:79], v[188:191], v[100:103], v[64:79]
    ds_read_b64_tr_b16 v[116:117], v9 offset:10240
    ds_read_b64_tr_b16 v[118:119], v9 offset:10496
    s_waitcnt lgkmcnt(4)
    v_mfma_f32_32x32x16_bf16 v[64:79], v[192:195], v[104:107], v[64:79]
    ds_read_b64_tr_b16 v[120:121], v9 offset:12288
    ds_read_b64_tr_b16 v[122:123], v9 offset:12544
    v_mfma_f32_32x32x16_bf16 v[64:79], v[196:199], v[108:111], v[64:79]
    ds_read_b64_tr_b16 v[96:97], v9 offset:14336
    ds_read_b64_tr_b16 v[98:99], v9 offset:14592
    s_waitcnt lgkmcnt(4)
    v_mfma_f32_32x32x16_bf16 v[64:79], v[200:203], v[112:115], v[64:79]
    ds_read_b64_tr_b16 v[100:101], v9 offset:16384
    ds_read_b64_tr_b16 v[102:103], v9 offset:16640
    v_mfma_f32_32x32x16_bf16 v[64:79], v[204:207], v[116:119], v[64:79]
    ds_read_b64_tr_b16 v[104:105], v9 offset:18432
    ds_read_b64_tr_b16 v[106:107], v9 offset:18688
    s_waitcnt lgkmcnt(4)
    v_mfma_f32_32x32x16_bf16 v[64:79], v[208:211], v[120:123], v[64:79]
    ds_read_b64_tr_b16 v[108:109], v9 offset:20480
    ds_read_b64_tr_b16 v[110:111], v9 offset:20736
    v_mfma_f32_32x32x16_bf16 v[64:79], v[212:215], v[96:99], v[64:79]
    ds_read_b64_tr_b16 v[112:113], v9 offset:22528
    ds_read_b64_tr_b16 v[114:115], v9 offset:22784
    s_waitcnt lgkmcnt(4)
    v_mfma_f32_32x32x16_bf16 v[64:79], v[216:219], v[100:103], v[64:79]
    ds_read_b64_tr_b16 v[116:117], v9 offset:24576
    ds_read_b64_tr_b16 v[118:119], v9 offset:24832
    v_mfma_f32_32x32x16_bf16 v[64:79], v[220:223], v[104:107], v[64:79]
    ds_read_b64_tr_b16 v[120:121], v9 offset:26624
    ds_read_b64_tr_b16 v[122:123], v9 offset:26880
    ds_read_u16 v240, v10
    s_waitcnt lgkmcnt(5)
    v_mfma_f32_32x32x16_bf16 v[64:79], v[224:227], v[108:111], v[64:79]
    ds_read_b64_tr_b16 v[96:97], v8 offset:0
    ds_read_b64_tr_b16 v[98:99], v8 offset:256
    v_mfma_f32_32x32x16_bf16 v[64:79], v[228:231], v[112:115], v[64:79]
    ds_read_b64_tr_b16 v[100:101], v8 offset:2048
    ds_read_b64_tr_b16 v[102:103], v8 offset:2304
    s_waitcnt lgkmcnt(5)
    v_mfma_f32_32x32x16_bf16 v[64:79], v[232:235], v[116:119], v[64:79]
    ds_read_b64_tr_b16 v[104:105], v8 offset:4096
    ds_read_b64_tr_b16 v[106:107], v8 offset:4352
    v_mfma_f32_32x32x16_bf16 v[80:95], v[236:239], v[120:123], v[64:79]
    ds_read_b64_tr_b16 v[108:109], v8 offset:6144
    ds_read_b64_tr_b16 v[110:111], v8 offset:6400
    s_lshr_b32 s69, s69, 2
    s_add_u32 s68, s68, 1
    s_cmp_lt_u32 s68, s50
    s_cbranch_scc1 M_TILE
M_DONE:
    v_mov_b32 v4, 161544
    v_mov_b32 v5, 1
    s_mov_b64 exec, 1
    ds_add_u32 v4, v5
    s_mov_b64 exec, -1
    v_readfirstlane_b32 s47, v61
    s_setprio 3
    s_waitcnt vmcnt(0)
    v_cmp_ne_u32 s[90:91], s47, v60
    s_mov_b64 exec, 3
    buffer_load_dword v61, v57, s[28:31], 0 offen sc1
    s_mov_b64 exec, -1
    v_lshlrev_b32 v4, 4, v1
    s_mov_b32 s83, 1
    s_and_b32 s82, s90, 0xffff
    s_cbranch_scc1 M_NOK
    s_add_u32 m0, s73, 0
    s_add_u32 s27, s75, 1835008
    buffer_load_dwordx4 v4, s[28:31], s27 offen sc1 lds
    s_mov_b32 exec_hi, 0xffff
    buffer_load_dwordx4 v4, s[28:31], s27 offen offset:1024 sc1 lds
    s_mov_b32 exec_hi, -1
    s_add_u32 m0, s73, 4096
    s_add_u32 s27, s76, 1835008
    buffer_load_dwordx4 v4, s[28:31], s27 offen sc1 lds
    s_mov_b32 exec_hi, 0xffff
    buffer_load_dwordx4 v4, s[28:31], s27 offen offset:1024 sc1 lds
    s_mov_b32 exec_hi, -1
    s_add_u32 m0, s73, 8192
    s_add_u32 s27, s77, 1835008
    buffer_load_dwordx4 v4, s[28:31], s27 offen sc1 lds
    s_mov_b32 exec_hi, 0xffff
    buffer_load_dwordx4 v4, s[28:31], s27 offen offset:1024 sc1 lds
    s_mov_b32 exec_hi, -1
    s_add_u32 m0, s73, 2048
    s_add_u32 s27, s75, 3670016
    buffer_load_dwordx4 v4, s[28:31], s27 offen sc1 lds
    s_mov_b32 exec_hi, 0xffff
    buffer_load_dwordx4 v4, s[28:31], s27 offen offset:1024 sc1 lds
    s_mov_b32 exec_hi, -1
    s_add_u32 m0, s73, 6144
    s_add_u32 s27, s76, 3670016
    buffer_load_dwordx4 v4, s[28:31], s27 offen sc1 lds
    s_mov_b32 exec_hi, 0xffff
    buffer_load_dwordx4 v4, s[28:31], s27 offen offset:1024 sc1 lds
    s_mov_b32 exec_hi, -1
    s_add_u32 m0, s73, 10240
    s_add_u32 s27, s77, 3670016
    buffer_load_dwordx4 v4, s[28:31], s27 offen sc1 lds
    s_mov_b32 exec_hi, 0xffff
    buffer_load_dwordx4 v4, s[28:31], s27 offen offset:1024 sc1 lds
    s_mov_b32 exec_hi, -1
    s_waitcnt vmcnt(12)
    v_cmp_ne_u32 s[88:89], s47, v61
    s_nop 0
    s_and_b32 s83, s88, 3
    s_cbranch_scc1 M_NOK
    buffer_load_dwordx2 v[48:49], v59, s[28:31], s74 offen offset:0 sc1
    buffer_load_dwordx2 v[50:51], v59, s[28:31], s74 offen offset:512 sc1
    buffer_load_dwordx2 v[52:53], v59, s[28:31], s74 offen offset:1024 sc1
    buffer_load_dwordx2 v[54:55], v59, s[28:31], s74 offen offset:1536 sc1
M_NOK:
    v_mul_f32 v16, v80, v80
    v_mul_f32 v17, v81, v81
    v_mul_f32 v18, v82, v82
    v_mul_f32 v19, v83, v83
    v_mul_f32 v20, v84, v84
    v_mul_f32 v21, v85, v85
    v_mul_f32 v22, v86, v86
    v_mul_f32 v23, v87, v87
    v_fma_f32 v16, v16, v6, v7
    v_fma_f32 v17, v17, v6, v7
    v_fma_f32 v18, v18, v6, v7
    v_fma_f32 v19, v19, v6, v7
    v_fma_f32 v20, v20, v6, v7
    v_fma_f32 v21, v21, v6, v7
    v_fma_f32 v22, v22, v6, v7
    v_fma_f32 v23, v23, v6, v7
    v_mul_f32 v16, v80, v16
    v_mul_f32 v17, v81, v17
    v_mul_f32 v18, v82, v18
    v_mul_f32 v19, v83, v19
    v_mul_f32 v20, v84, v20
    v_mul_f32 v21, v85, v21
    v_mul_f32 v22, v86, v22
    v_mul_f32 v23, v87, v23
    v_exp_f32 v16, v16
    v_exp_f32 v17, v17
    v_exp_f32 v18, v18
    v_exp_f32 v19, v19
    v_exp_f32 v20, v20
    v_exp_f32 v21, v21
    v_exp_f32 v22, v22
    v_exp_f32 v23, v23
    v_fma_f32 v16, v16, v15, v15
    v_fma_f32 v17, v17, v15, v15
    v_fma_f32 v18, v18, v15, v15
    v_fma_f32 v19, v19, v15, v15
    v_fma_f32 v20, v20, v15, v15
    v_fma_f32 v21, v21, v15, v15
    v_fma_f32 v22, v22, v15, v15
    v_fma_f32 v23, v23, v15, v15
    v_rcp_f32 v16, v16
    v_rcp_f32 v17, v17
    v_rcp_f32 v18, v18
    v_rcp_f32 v19, v19
    v_rcp_f32 v20, v20
    v_rcp_f32 v21, v21
    v_rcp_f32 v22, v22
    v_rcp_f32 v23, v23
    v_mul_f32 v16, v80, v16
    v_mul_f32 v17, v81, v17
    v_mul_f32 v18, v82, v18
    v_mul_f32 v19, v83, v19
    v_mul_f32 v20, v84, v20
    v_mul_f32 v21, v85, v21
    v_mul_f32 v22, v86, v22
    v_mul_f32 v23, v87, v23
    v_cvt_pk_bf16_f32 v32, v16, v17
    v_cvt_pk_bf16_f32 v33, v18, v19
    v_cvt_pk_bf16_f32 v34, v20, v21
    v_cvt_pk_bf16_f32 v35, v22, v23
    buffer_store_dwordx4 v[32:35], v4, s[28:31], s84 offen offset:0 sc1
    v_mul_f32 v24, v88, v88
    v_mul_f32 v25, v89, v89
    v_mul_f32 v26, v90, v90
    v_mul_f32 v27, v91, v91
    v_mul_f32 v28, v92, v92
    v_mul_f32 v29, v93, v93
    v_mul_f32 v30, v94, v94
    v_mul_f32 v31, v95, v95
    v_fma_f32 v24, v24, v6, v7
    v_fma_f32 v25, v25, v6, v7
    v_fma_f32 v26, v26, v6, v7
    v_fma_f32 v27, v27, v6, v7
    v_fma_f32 v28, v28, v6, v7
    v_fma_f32 v29, v29, v6, v7
    v_fma_f32 v30, v30, v6, v7
    v_fma_f32 v31, v31, v6, v7
    v_mul_f32 v24, v88, v24
    v_mul_f32 v25, v89, v25
    v_mul_f32 v26, v90, v26
    v_mul_f32 v27, v91, v27
    v_mul_f32 v28, v92, v28
    v_mul_f32 v29, v93, v29
    v_mul_f32 v30, v94, v30
    v_mul_f32 v31, v95, v31
    v_exp_f32 v24, v24
    v_exp_f32 v25, v25
    v_exp_f32 v26, v26
    v_exp_f32 v27, v27
    v_exp_f32 v28, v28
    v_exp_f32 v29, v29
    v_exp_f32 v30, v30
    v_exp_f32 v31, v31
    v_fma_f32 v24, v24, v15, v15
    v_fma_f32 v25, v25, v15, v15
    v_fma_f32 v26, v26, v15, v15
    v_fma_f32 v27, v27, v15, v15
    v_fma_f32 v28, v28, v15, v15
    v_fma_f32 v29, v29, v15, v15
    v_fma_f32 v30, v30, v15, v15
    v_fma_f32 v31, v31, v15, v15
    v_rcp_f32 v24, v24
    v_rcp_f32 v25, v25
    v_rcp_f32 v26, v26
    v_rcp_f32 v27, v27
    v_rcp_f32 v28, v28
    v_rcp_f32 v29, v29
    v_rcp_f32 v30, v30
    v_rcp_f32 v31, v31
    v_mul_f32 v24, v88, v24
    v_mul_f32 v25, v89, v25
    v_mul_f32 v26, v90, v26
    v_mul_f32 v27, v91, v27
    v_mul_f32 v28, v92, v28
    v_mul_f32 v29, v93, v29
    v_mul_f32 v30, v94, v30
    v_mul_f32 v31, v95, v31
    v_cvt_pk_bf16_f32 v36, v24, v25
    v_cvt_pk_bf16_f32 v37, v26, v27
    v_cvt_pk_bf16_f32 v38, v28, v29
    v_cvt_pk_bf16_f32 v39, v30, v31
    buffer_store_dwordx4 v[36:39], v4, s[28:31], s84 offen offset:1024 sc1
    s_setprio 0
    v_mov_b32 v8, 0x3f803f80
    v_mov_b32 v9, 0x3f803f80
    v_mov_b32 v10, 0x3f803f80
    v_mov_b32 v11, 0x3f803f80
    v_min_u32 v12, 2, v1
    v_lshl_add_u32 v12, v12, 12, s73
    ds_write_b128 v12, v[8:11] offset:3840
    v_lshl_add_u32 v12, v1, 2, s73
    s_mov_b32 vcc_lo, 0x55555555
    s_mov_b32 vcc_hi, 0x55555555
    s_cmp_lt_u32 s75, 0x40000000
    s_cselect_b32 s27, 0, 0xf149
    v_mov_b32 v11, s27
    v_cndmask_b32 v8, 0, v11, vcc
    ds_write_b32 v12, v8 offset:1792
    s_cmp_lt_u32 s76, 0x40000000
    s_cselect_b32 s27, 0, 0xf149
    v_mov_b32 v11, s27
    v_cndmask_b32 v9, 0, v11, vcc
    ds_write_b32 v12, v9 offset:5888
    s_cmp_lt_u32 s77, 0x40000000
    s_cselect_b32 s27, 0, 0xf149
    v_mov_b32 v11, s27
    v_cndmask_b32 v10, 0, v11, vcc
    ds_write_b32 v12, v10 offset:9984
    s_waitcnt vmcnt(0)
    v_mov_b32 v10, s47
    v_mov_b32 v11, 0
    s_mov_b64 exec, 1
    buffer_store_dword v10, v11, s[28:31], s85 offen sc1
    s_mov_b64 exec, -1
    s_cmp_eq_u32 s82, 0
    s_cbranch_scc1 A_KOK
    s_mov_b32 s27, 65536
    s_mov_b64 exec, 65535
    s_branch A_PK_L
A_PK:
    s_mov_b64 exec, s[88:89]
    s_sleep 3
A_PK_L:
    buffer_load_dword v60, v56, s[28:31], 0 offen sc1
    s_waitcnt vmcnt(0)
    v_cmp_ne_u32 s[88:89], s47, v60
    s_sub_u32 s27, s27, 1
    s_cbranch_scc1 A_PK_X
    s_cmp_lg_u64 s[88:89], 0
    s_cbranch_scc1 A_PK
A_PK_X:
    s_mov_b64 exec, -1
    s_add_u32 m0, s73, 0
    s_add_u32 s27, s75, 1835008
    buffer_load_dwordx4 v4, s[28:31], s27 offen sc1 lds
    s_mov_b32 exec_hi, 0xffff
    buffer_load_dwordx4 v4, s[28:31], s27 offen offset:1024 sc1 lds
    s_mov_b32 exec_hi, -1
    s_add_u32 m0, s73, 4096
    s_add_u32 s27, s76, 1835008
    buffer_load_dwordx4 v4, s[28:31], s27 offen sc1 lds
    s_mov_b32 exec_hi, 0xffff
    buffer_load_dwordx4 v4, s[28:31], s27 offen offset:1024 sc1 lds
    s_mov_b32 exec_hi, -1
    s_add_u32 m0, s73, 8192
    s_add_u32 s27, s77, 1835008
    buffer_load_dwordx4 v4, s[28:31], s27 offen sc1 lds
    s_mov_b32 exec_hi, 0xffff
    buffer_load_dwordx4 v4, s[28:31], s27 offen offset:1024 sc1 lds
    s_mov_b32 exec_hi, -1
    s_add_u32 m0, s73, 2048
    s_add_u32 s27, s75, 3670016
    buffer_load_dwordx4 v4, s[28:31], s27 offen sc1 lds
    s_mov_b32 exec_hi, 0xffff
    buffer_load_dwordx4 v4, s[28:31], s27 offen offset:1024 sc1 lds
    s_mov_b32 exec_hi, -1
    s_add_u32 m0, s73, 6144
    s_add_u32 s27, s76, 3670016
    buffer_load_dwordx4 v4, s[28:31], s27 offen sc1 lds
    s_mov_b32 exec_hi, 0xffff
    buffer_load_dwordx4 v4, s[28:31], s27 offen offset:1024 sc1 lds
    s_mov_b32 exec_hi, -1
    s_add_u32 m0, s73, 10240
    s_add_u32 s27, s77, 3670016
    buffer_load_dwordx4 v4, s[28:31], s27 offen sc1 lds
    s_mov_b32 exec_hi, 0xffff
    buffer_load_dwordx4 v4, s[28:31], s27 offen offset:1024 sc1 lds
    s_mov_b32 exec_hi, -1
    s_waitcnt vmcnt(0)
A_KOK:
    s_waitcnt lgkmcnt(0)
    v_mov_b32 v8, 161536
    v_mov_b32 v9, 1
    s_mov_b64 exec, 1
    ds_add_u32 v8, v9
    s_mov_b64 exec, -1
    s_cmp_eq_u32 s83, 0
    s_cbranch_scc1 A_QOK
    s_mov_b32 s27, 65536
    s_mov_b64 exec, 3
    s_branch A_PQ_L
A_PQ:
    s_mov_b64 exec, s[88:89]
    s_sleep 3
A_PQ_L:
    buffer_load_dword v60, v57, s[28:31], 0 offen sc1
    s_waitcnt vmcnt(0)
    v_cmp_ne_u32 s[88:89], s47, v60
    s_sub_u32 s27, s27, 1
    s_cbranch_scc1 A_PQ_X
    s_cmp_lg_u64 s[88:89], 0
    s_cbranch_scc1 A_PQ
A_PQ_X:
    s_mov_b64 exec, -1
    buffer_load_dwordx2 v[48:49], v59, s[28:31], s74 offen offset:0 sc1
    buffer_load_dwordx2 v[50:51], v59, s[28:31], s74 offen offset:512 sc1
    buffer_load_dwordx2 v[52:53], v59, s[28:31], s74 offen offset:1024 sc1
    buffer_load_dwordx2 v[54:55], v59, s[28:31], s74 offen offset:1536 sc1
    s_waitcnt vmcnt(0)
A_QOK:
    v_cmp_eq_u32 vcc, 0, v3
    v_mov_b32 v5, 0x3f80
    v_mov_b32 v15, 0xff61b1e6
    v_cndmask_b32 v54, v5, v54, vcc
    v_cndmask_b32 v55, 0, v55, vcc
    s_setprio 2
    s_mov_b32 s27, 4194304
    s_branch A_LB0_L
A_LB0:
    s_sleep 1
A_LB0_L:
    ds_read_b32 v9, v8
    s_waitcnt lgkmcnt(0)
    v_readfirstlane_b32 s88, v9
    s_sub_u32 s27, s27, 1
    s_cbranch_scc1 A_LB0_X
    s_cmp_lt_u32 s88, 4
    s_cbranch_scc1 A_LB0
A_LB0_X:
    ds_read_b64 v[128:129], v124 offset:32768
    ds_read_b64 v[130:131], v124 offset:33280
    ds_read_b64 v[132:133], v124 offset:33792
    ds_read_b64 v[134:135], v124 offset:34304
    ds_read_b64 v[192:193], v124 offset:0
    ds_read_b64 v[194:195], v124 offset:512
    ds_read_b64 v[196:197], v124 offset:1024
    ds_read_b64 v[198:199], v124 offset:1536
    ds_read_b64 v[136:137], v124 offset:28672
    ds_read_b64 v[138:139], v124 offset:29184
    ds_read_b64 v[140:141], v124 offset:29696
    ds_read_b64 v[142:143], v124 offset:30208
    s_waitcnt lgkmcnt(8)
    v_mfma_f32_32x32x16_bf16 v[232:247], v[128:131], v[48:51], 0
    ds_read_b64 v[144:145], v124 offset:24576
    ds_read_b64 v[146:147], v124 offset:25088
    ds_read_b64 v[148:149], v124 offset:25600
    ds_read_b64 v[150:151], v124 offset:26112
    s_nop 1
    v_mfma_f32_32x32x16_bf16 v[232:247], v[132:135], v[52:55], v[232:247]
    s_nop 1
    s_waitcnt lgkmcnt(8)
    v_mfma_f32_32x32x16_bf16 v[216:231], v[192:195], v[48:51], 0
    ds_read_b64 v[152:153], v124 offset:20480
    ds_read_b64 v[154:155], v124 offset:20992
    ds_read_b64 v[156:157], v124 offset:21504
    ds_read_b64 v[158:159], v124 offset:22016
    s_nop 1
    v_mfma_f32_32x32x16_bf16 v[216:231], v[196:199], v[52:55], v[216:231]
    s_nop 1
    s_waitcnt lgkmcnt(8)
    v_mfma_f32_32x32x16_bf16 v[64:79], v[136:139], v[48:51], 0
    ds_read_b64 v[160:161], v124 offset:16384
    ds_read_b64 v[162:163], v124 offset:16896
    ds_read_b64 v[164:165], v124 offset:17408
    ds_read_b64 v[166:167], v124 offset:17920
    s_nop 1
    s_nop 1
    v_mfma_f32_32x32x16_bf16 v[64:79], v[140:143], v[52:55], v[64:79]
    s_nop 1
    s_nop 1
    s_waitcnt lgkmcnt(8)
    v_mfma_f32_32x32x16_bf16 v[80:95], v[144:147], v[48:51], 0
    ds_read_b64 v[168:169], v124 offset:12288
    ds_read_b64 v[170:171], v124 offset:12800
    ds_read_b64 v[172:173], v124 offset:13312
    ds_read_b64 v[174:175], v124 offset:13824
    v_cndmask_b32 v232, v216, v232, s[4:5]
    v_cndmask_b32 v233, v217, v233, s[6:7]
    v_cndmask_b32 v234, v218, v234, s[8:9]
    v_cndmask_b32 v235, v219, v235, s[10:11]
    v_cndmask_b32 v236, v220, v236, s[12:13]
    v_cndmask_b32 v237, v221, v237, s[14:15]
    v_mfma_f32_32x32x16_bf16 v[80:95], v[148:151], v[52:55], v[80:95]
    v_cndmask_b32 v238, v222, v238, s[16:17]
    v_cndmask_b32 v239, v223, v239, s[18:19]
    v_cndmask_b32 v240, v224, v240, s[20:21]
    v_cndmask_b32 v241, v225, v241, s[22:23]
    v_cndmask_b32 v242, v226, v242, s[40:41]
    v_cndmask_b32 v243, v227, v243, s[42:43]
    s_waitcnt lgkmcnt(8)
    v_mfma_f32_32x32x16_bf16 v[96:111], v[152:155], v[48:51], 0
    ds_read_b64 v[176:177], v124 offset:8192
    ds_read_b64 v[178:179], v124 offset:8704
    ds_read_b64 v[180:181], v124 offset:9216
    ds_read_b64 v[182:183], v124 offset:9728
    v_cndmask_b32 v244, v228, v244, s[44:45]
    v_cndmask_b32 v245, v229, v245, s[92:93]
    v_cndmask_b32 v246, v230, v246, s[94:95]
    v_cndmask_b32 v247, v231, v247, s[100:101]
    v_max3_f32 v15, v64, v65, v15
    v_max3_f32 v15, v66, v67, v15
    v_mfma_f32_32x32x16_bf16 v[96:111], v[156:159], v[52:55], v[96:111]
    v_max3_f32 v15, v68, v69, v15
    v_max3_f32 v15, v70, v71, v15
    v_max3_f32 v15, v72, v73, v15
    v_max3_f32 v15, v74, v75, v15
    v_max3_f32 v15, v76, v77, v15
    v_max3_f32 v15, v78, v79, v15
    s_waitcnt lgkmcnt(8)
    v_mfma_f32_32x32x16_bf16 v[64:79], v[160:163], v[48:51], 0
    ds_read_b64 v[184:185], v124 offset:4096
    ds_read_b64 v[186:187], v124 offset:4608
    ds_read_b64 v[188:189], v124 offset:5120
    ds_read_b64 v[190:191], v124 offset:5632
    v_max3_f32 v15, v80, v81, v15
    v_max3_f32 v15, v82, v83, v15
    v_max3_f32 v15, v84, v85, v15
    v_max3_f32 v15, v86, v87, v15
    v_max3_f32 v15, v88, v89, v15
    v_max3_f32 v15, v90, v91, v15
    v_mfma_f32_32x32x16_bf16 v[64:79], v[164:167], v[52:55], v[64:79]
    v_max3_f32 v15, v92, v93, v15
    v_max3_f32 v15, v94, v95, v15
    v_max3_f32 v15, v232, v233, v15
    v_max3_f32 v15, v234, v235, v15
    v_max3_f32 v15, v236, v237, v15
    v_max3_f32 v15, v238, v239, v15
    s_waitcnt lgkmcnt(8)
    v_mfma_f32_32x32x16_bf16 v[80:95], v[168:171], v[48:51], 0
    v_max3_f32 v15, v96, v97, v15
    v_max3_f32 v15, v98, v99, v15
    v_max3_f32 v15, v100, v101, v15
    v_max3_f32 v15, v102, v103, v15
    v_max3_f32 v15, v104, v105, v15
    v_max3_f32 v15, v106, v107, v15
    v_mfma_f32_32x32x16_bf16 v[80:95], v[172:175], v[52:55], v[80:95]
    v_max3_f32 v15, v108, v109, v15
    v_max3_f32 v15, v110, v111, v15
    v_max3_f32 v15, v240, v241, v15
    v_max3_f32 v15, v242, v243, v15
    v_max3_f32 v15, v244, v245, v15
    v_max3_f32 v15, v246, v247, v15
    s_waitcnt lgkmcnt(4)
    v_mfma_f32_32x32x16_bf16 v[96:111], v[176:179], v[48:51], 0
    v_max3_f32 v15, v64, v65, v15
    v_max3_f32 v15, v66, v67, v15
    v_max3_f32 v15, v68, v69, v15
    v_max3_f32 v15, v70, v71, v15
    v_mfma_f32_32x32x16_bf16 v[96:111], v[180:183], v[52:55], v[96:111]
    v_max3_f32 v15, v72, v73, v15
    v_max3_f32 v15, v74, v75, v15
    v_max3_f32 v15, v76, v77, v15
    v_max3_f32 v15, v78, v79, v15
    s_waitcnt lgkmcnt(0)
    v_mfma_f32_32x32x16_bf16 v[64:79], v[184:187], v[48:51], 0
    v_max3_f32 v15, v80, v81, v15
    v_max3_f32 v15, v82, v83, v15
    v_max3_f32 v15, v84, v85, v15
    v_max3_f32 v15, v86, v87, v15
    v_mfma_f32_32x32x16_bf16 v[64:79], v[188:191], v[52:55], v[64:79]
    v_max3_f32 v15, v88, v89, v15
    v_max3_f32 v15, v90, v91, v15
    v_max3_f32 v15, v92, v93, v15
    v_max3_f32 v15, v94, v95, v15
    v_max3_f32 v15, v96, v97, v15
    v_max3_f32 v15, v98, v99, v15
    v_max3_f32 v15, v100, v101, v15
    v_max3_f32 v15, v102, v103, v15
    v_max3_f32 v15, v104, v105, v15
    v_max3_f32 v15, v106, v107, v15
    v_max3_f32 v15, v108, v109, v15
    v_max3_f32 v15, v110, v111, v15
    s_nop 1
    v_max3_f32 v15, v64, v65, v15
    v_max3_f32 v15, v66, v67, v15
    v_max3_f32 v15, v68, v69, v15
    v_max3_f32 v15, v70, v71, v15
    v_max3_f32 v15, v72, v73, v15
    v_max3_f32 v15, v74, v75, v15
    v_max3_f32 v15, v76, v77, v15
    v_max3_f32 v15, v78, v79, v15
    v_mov_b32 v8, v15
    s_nop 1
    v_permlane32_swap_b32 v8, v15
    v_max_f32 v15, v8, v15
    v_xor_b32 v14, 0x80000000, v15
    v_mov_b32 v216, v14
    v_mov_b32 v217, v14
    v_mov_b32 v218, v14
    v_mov_b32 v219, v14
    v_mov_b32 v220, v14
    v_mov_b32 v221, v14
    v_mov_b32 v222, v14
    v_mov_b32 v223, v14
    v_mov_b32 v224, v14
    v_mov_b32 v225, v14
    v_mov_b32 v226, v14
    v_mov_b32 v227, v14
    v_mov_b32 v228, v14
    v_mov_b32 v229, v14
    v_mov_b32 v230, v14
    v_mov_b32 v231, v14
    ds_read_b128 v[16:19], v125 offset:32768
    ds_read_b128 v[20:23], v126 offset:32768
    ds_read_b128 v[24:27], v125 offset:0
    ds_read_b128 v[28:31], v126 offset:0
    v_sub_f32 v232, v232, v15
    v_sub_f32 v233, v233, v15
    v_mfma_f32_32x32x16_bf16 v[80:95], v[136:139], v[48:51], v[216:231]
    v_sub_f32 v234, v234, v15
    v_sub_f32 v235, v235, v15
    v_sub_f32 v236, v236, v15
    v_sub_f32 v237, v237, v15
    v_sub_f32 v238, v238, v15
    v_sub_f32 v239, v239, v15
    v_sub_f32 v240, v240, v15
    v_sub_f32 v241, v241, v15
    v_mfma_f32_32x32x16_bf16 v[80:95], v[140:143], v[52:55], v[80:95]
    v_sub_f32 v242, v242, v15
    v_sub_f32 v243, v243, v15
    v_sub_f32 v244, v244, v15
    v_sub_f32 v245, v245, v15
    v_sub_f32 v246, v246, v15
    v_sub_f32 v247, v247, v15
    v_exp_f32 v232, v232
    v_exp_f32 v233, v233
    v_exp_f32 v234, v234
    v_exp_f32 v235, v235
    v_exp_f32 v236, v236
    v_exp_f32 v237, v237
    v_exp_f32 v238, v238
    v_exp_f32 v239, v239
    v_cvt_pk_bf16_f32 v192, v232, v233
    v_cvt_pk_bf16_f32 v193, v234, v235
    v_cvt_pk_bf16_f32 v194, v236, v237
    v_cvt_pk_bf16_f32 v195, v238, v239
    v_exp_f32 v240, v240
    v_exp_f32 v241, v241
    v_exp_f32 v242, v242
    v_exp_f32 v243, v243
    v_exp_f32 v244, v244
    v_exp_f32 v245, v245
    v_exp_f32 v246, v246
    v_exp_f32 v247, v247
    v_cvt_pk_bf16_f32 v196, v240, v241
    v_cvt_pk_bf16_f32 v197, v242, v243
    v_cvt_pk_bf16_f32 v198, v244, v245
    v_cvt_pk_bf16_f32 v199, v246, v247
    v_and_b32 v128, v248, v192
    v_xor_b32 v192, v128, v192
    v_and_b32 v129, v249, v193
    v_xor_b32 v193, v129, v193
    v_and_b32 v130, v250, v194
    v_xor_b32 v194, v130, v194
    v_and_b32 v131, v251, v195
    v_xor_b32 v195, v131, v195
    v_and_b32 v132, v252, v196
    v_xor_b32 v196, v132, v196
    v_and_b32 v133, v253, v197
    v_xor_b32 v197, v133, v197
    v_and_b32 v134, v254, v198
    v_xor_b32 v198, v134, v198
    v_and_b32 v135, v255, v199
    v_xor_b32 v199, v135, v199
    v_mfma_f32_32x32x16_bf16 v[96:111], v[144:147], v[48:51], v[216:231]
    v_exp_f32 v80, v80
    v_exp_f32 v81, v81
    v_exp_f32 v82, v82
    v_exp_f32 v83, v83
    v_mfma_f32_32x32x16_bf16 v[96:111], v[148:151], v[52:55], v[96:111]
    v_exp_f32 v84, v84
    v_exp_f32 v85, v85
    v_exp_f32 v86, v86
    v_exp_f32 v87, v87
    s_waitcnt lgkmcnt(2)
    v_mfma_f32_32x32x16_bf16 v[200:215], v[16:19], v[128:131], 0
    v_cvt_pk_bf16_f32 v40, v80, v81
    v_cvt_pk_bf16_f32 v41, v82, v83
    v_cvt_pk_bf16_f32 v42, v84, v85
    v_cvt_pk_bf16_f32 v43, v86, v87
    v_mfma_f32_32x32x16_bf16 v[200:215], v[20:23], v[132:135], v[200:215]
    ds_read_b128 v[16:19], v125 offset:28672
    ds_read_b128 v[20:23], v126 offset:28672
    v_exp_f32 v88, v88
    v_exp_f32 v89, v89
    v_exp_f32 v90, v90
    v_exp_f32 v91, v91
    s_waitcnt lgkmcnt(2)
    v_mfma_f32_32x32x16_bf16 v[200:215], v[24:27], v[192:195], v[200:215]
    v_exp_f32 v92, v92
    v_exp_f32 v93, v93
    v_exp_f32 v94, v94
    v_exp_f32 v95, v95
    v_mfma_f32_32x32x16_bf16 v[200:215], v[28:31], v[196:199], v[200:215]
    ds_read_b128 v[24:27], v125 offset:24576
    ds_read_b128 v[28:31], v126 offset:24576
    v_cvt_pk_bf16_f32 v44, v88, v89
    v_cvt_pk_bf16_f32 v45, v90, v91
    v_cvt_pk_bf16_f32 v46, v92, v93
    v_cvt_pk_bf16_f32 v47, v94, v95
    v_mfma_f32_32x32x16_bf16 v[64:79], v[152:155], v[48:51], v[216:231]
    v_exp_f32 v96, v96
    v_exp_f32 v97, v97
    v_exp_f32 v98, v98
    v_exp_f32 v99, v99
    v_exp_f32 v100, v100
    v_exp_f32 v101, v101
    v_mfma_f32_32x32x16_bf16 v[64:79], v[156:159], v[52:55], v[64:79]
    v_exp_f32 v102, v102
    v_exp_f32 v103, v103
    v_cvt_pk_bf16_f32 v112, v96, v97
    v_cvt_pk_bf16_f32 v113, v98, v99
    v_cvt_pk_bf16_f32 v114, v100, v101
    v_cvt_pk_bf16_f32 v115, v102, v103
    s_waitcnt lgkmcnt(2)
    v_mfma_f32_32x32x16_bf16 v[200:215], v[16:19], v[40:43], v[200:215]
    v_exp_f32 v104, v104
    v_exp_f32 v105, v105
    v_exp_f32 v106, v106
    v_exp_f32 v107, v107
    v_exp_f32 v108, v108
    v_exp_f32 v109, v109
    v_mfma_f32_32x32x16_bf16 v[200:215], v[20:23], v[44:47], v[200:215]
    ds_read_b128 v[16:19], v125 offset:20480
    ds_read_b128 v[20:23], v126 offset:20480
    v_exp_f32 v110, v110
    v_exp_f32 v111, v111
    v_cvt_pk_bf16_f32 v116, v104, v105
    v_cvt_pk_bf16_f32 v117, v106, v107
    v_cvt_pk_bf16_f32 v118, v108, v109
    v_cvt_pk_bf16_f32 v119, v110, v111
    v_mfma_f32_32x32x16_bf16 v[80:95], v[160:163], v[48:51], v[216:231]
    v_exp_f32 v64, v64
    v_exp_f32 v65, v65
    v_exp_f32 v66, v66
    v_exp_f32 v67, v67
    v_exp_f32 v68, v68
    v_exp_f32 v69, v69
    v_mfma_f32_32x32x16_bf16 v[80:95], v[164:167], v[52:55], v[80:95]
    v_exp_f32 v70, v70
    v_exp_f32 v71, v71
    v_cvt_pk_bf16_f32 v32, v64, v65
    v_cvt_pk_bf16_f32 v33, v66, v67
    v_cvt_pk_bf16_f32 v34, v68, v69
    v_cvt_pk_bf16_f32 v35, v70, v71
    s_waitcnt lgkmcnt(2)
    v_mfma_f32_32x32x16_bf16 v[200:215], v[24:27], v[112:115], v[200:215]
    v_exp_f32 v72, v72
    v_exp_f32 v73, v73
    v_exp_f32 v74, v74
    v_exp_f32 v75, v75
    v_exp_f32 v76, v76
    v_exp_f32 v77, v77
    v_mfma_f32_32x32x16_bf16 v[200:215], v[28:31], v[116:119], v[200:215]
    ds_read_b128 v[24:27], v125 offset:16384
    ds_read_b128 v[28:31], v126 offset:16384
    v_exp_f32 v78, v78
    v_exp_f32 v79, v79
    v_cvt_pk_bf16_f32 v36, v72, v73
    v_cvt_pk_bf16_f32 v37, v74, v75
    v_cvt_pk_bf16_f32 v38, v76, v77
    v_cvt_pk_bf16_f32 v39, v78, v79
    v_mfma_f32_32x32x16_bf16 v[96:111], v[168:171], v[48:51], v[216:231]
    v_exp_f32 v80, v80
    v_exp_f32 v81, v81
    v_exp_f32 v82, v82
    v_exp_f32 v83, v83
    v_exp_f32 v84, v84
    v_exp_f32 v85, v85
    v_mfma_f32_32x32x16_bf16 v[96:111], v[172:175], v[52:55], v[96:111]
    v_exp_f32 v86, v86
    v_exp_f32 v87, v87
    v_cvt_pk_bf16_f32 v40, v80, v81
    v_cvt_pk_bf16_f32 v41, v82, v83
    v_cvt_pk_bf16_f32 v42, v84, v85
    v_cvt_pk_bf16_f32 v43, v86, v87
    s_waitcnt lgkmcnt(2)
    v_mfma_f32_32x32x16_bf16 v[200:215], v[16:19], v[32:35], v[200:215]
    v_exp_f32 v88, v88
    v_exp_f32 v89, v89
    v_exp_f32 v90, v90
    v_exp_f32 v91, v91
    v_exp_f32 v92, v92
    v_exp_f32 v93, v93
    v_mfma_f32_32x32x16_bf16 v[200:215], v[20:23], v[36:39], v[200:215]
    ds_read_b128 v[16:19], v125 offset:12288
    ds_read_b128 v[20:23], v126 offset:12288
    v_exp_f32 v94, v94
    v_exp_f32 v95, v95
    v_cvt_pk_bf16_f32 v44, v88, v89
    v_cvt_pk_bf16_f32 v45, v90, v91
    v_cvt_pk_bf16_f32 v46, v92, v93
    v_cvt_pk_bf16_f32 v47, v94, v95
    v_mfma_f32_32x32x16_bf16 v[64:79], v[176:179], v[48:51], v[216:231]
    v_exp_f32 v96, v96
    v_exp_f32 v97, v97
    v_exp_f32 v98, v98
    v_exp_f32 v99, v99
    v_exp_f32 v100, v100
    v_exp_f32 v101, v101
    v_mfma_f32_32x32x16_bf16 v[64:79], v[180:183], v[52:55], v[64:79]
    v_exp_f32 v102, v102
    v_exp_f32 v103, v103
    v_cvt_pk_bf16_f32 v112, v96, v97
    v_cvt_pk_bf16_f32 v113, v98, v99
    v_cvt_pk_bf16_f32 v114, v100, v101
    v_cvt_pk_bf16_f32 v115, v102, v103
    s_waitcnt lgkmcnt(2)
    v_mfma_f32_32x32x16_bf16 v[200:215], v[24:27], v[40:43], v[200:215]
    v_exp_f32 v104, v104
    v_exp_f32 v105, v105
    v_exp_f32 v106, v106
    v_exp_f32 v107, v107
    v_exp_f32 v108, v108
    v_exp_f32 v109, v109
    v_mfma_f32_32x32x16_bf16 v[200:215], v[28:31], v[44:47], v[200:215]
    ds_read_b128 v[24:27], v125 offset:8192
    ds_read_b128 v[28:31], v126 offset:8192
    v_exp_f32 v110, v110
    v_exp_f32 v111, v111
    v_cvt_pk_bf16_f32 v116, v104, v105
    v_cvt_pk_bf16_f32 v117, v106, v107
    v_cvt_pk_bf16_f32 v118, v108, v109
    v_cvt_pk_bf16_f32 v119, v110, v111
    v_mfma_f32_32x32x16_bf16 v[80:95], v[184:187], v[48:51], v[216:231]
    v_exp_f32 v64, v64
    v_exp_f32 v65, v65
    v_exp_f32 v66, v66
    v_exp_f32 v67, v67
    v_exp_f32 v68, v68
    v_exp_f32 v69, v69
    v_mfma_f32_32x32x16_bf16 v[80:95], v[188:191], v[52:55], v[80:95]
    v_exp_f32 v70, v70
    v_exp_f32 v71, v71
    v_cvt_pk_bf16_f32 v32, v64, v65
    v_cvt_pk_bf16_f32 v33, v66, v67
    v_cvt_pk_bf16_f32 v34, v68, v69
    v_cvt_pk_bf16_f32 v35, v70, v71
    s_waitcnt lgkmcnt(2)
    v_mfma_f32_32x32x16_bf16 v[200:215], v[16:19], v[112:115], v[200:215]
    v_exp_f32 v72, v72
    v_exp_f32 v73, v73
    v_exp_f32 v74, v74
    v_exp_f32 v75, v75
    v_exp_f32 v76, v76
    v_exp_f32 v77, v77
    v_mfma_f32_32x32x16_bf16 v[200:215], v[20:23], v[116:119], v[200:215]
    ds_read_b128 v[16:19], v125 offset:4096
    ds_read_b128 v[20:23], v126 offset:4096
    v_exp_f32 v78, v78
    v_exp_f32 v79, v79
    v_cvt_pk_bf16_f32 v36, v72, v73
    v_cvt_pk_bf16_f32 v37, v74, v75
    v_cvt_pk_bf16_f32 v38, v76, v77
    v_cvt_pk_bf16_f32 v39, v78, v79
    s_waitcnt lgkmcnt(2)
    v_mfma_f32_32x32x16_bf16 v[200:215], v[24:27], v[32:35], v[200:215]
    v_exp_f32 v80, v80
    v_exp_f32 v81, v81
    v_exp_f32 v82, v82
    v_exp_f32 v83, v83
    v_exp_f32 v84, v84
    v_exp_f32 v85, v85
    v_exp_f32 v86, v86
    v_exp_f32 v87, v87
    v_mfma_f32_32x32x16_bf16 v[200:215], v[28:31], v[36:39], v[200:215]
    v_cvt_pk_bf16_f32 v40, v80, v81
    v_cvt_pk_bf16_f32 v41, v82, v83
    v_cvt_pk_bf16_f32 v42, v84, v85
    v_cvt_pk_bf16_f32 v43, v86, v87
    v_exp_f32 v88, v88
    v_exp_f32 v89, v89
    v_exp_f32 v90, v90
    v_exp_f32 v91, v91
    s_waitcnt lgkmcnt(0)
    v_mfma_f32_32x32x16_bf16 v[200:215], v[16:19], v[40:43], v[200:215]
    v_exp_f32 v92, v92
    v_exp_f32 v93, v93
    v_exp_f32 v94, v94
    v_exp_f32 v95, v95
    v_cvt_pk_bf16_f32 v44, v88, v89
    v_cvt_pk_bf16_f32 v45, v90, v91
    v_cvt_pk_bf16_f32 v46, v92, v93
    v_cvt_pk_bf16_f32 v47, v94, v95
    s_nop 1
    v_mfma_f32_32x32x16_bf16 v[200:215], v[20:23], v[44:47], v[200:215]
A_FIN:
    s_mul_i32 s41, s71, 147456
    s_lshl_b32 s42, s70, 11
    s_add_u32 s41, s41, s42
    s_add_u32 s41, s41, 5619712
    s_mul_i32 s42, s71, 14592
    s_lshl_b32 s27, s70, 7
    s_add_u32 s42, s42, s27
    s_add_u32 s42, s42, 14954752
    v_mov_b32 v10, s47
    v_mov_b32 v11, 0
    s_nop 1
    v_mov_b32 v8, v212
    v_mov_b32 v9, v212
    s_nop 1
    v_permlane32_swap_b32 v8, v9
    v_rcp_f32 v9, v9
    s_nop 0
    v_mul_f32 v200, v9, v200
    v_mul_f32 v201, v9, v201
    v_mul_f32 v202, v9, v202
    v_mul_f32 v203, v9, v203
    v_mul_f32 v204, v9, v204
    v_mul_f32 v205, v9, v205
    v_mul_f32 v206, v9, v206
    v_mul_f32 v207, v9, v207
    v_cvt_pk_bf16_f32 v32, v200, v201
    v_cvt_pk_bf16_f32 v33, v202, v203
    v_cvt_pk_bf16_f32 v34, v204, v205
    v_cvt_pk_bf16_f32 v35, v206, v207
    buffer_store_dwordx4 v[32:35], v4, s[28:31], s41 offen offset:0 sc1
    v_mul_f32 v208, v9, v208
    v_mul_f32 v209, v9, v209
    v_mul_f32 v210, v9, v210
    v_mul_f32 v211, v9, v211
    v_mul_f32 v212, v9, v212
    v_mul_f32 v213, v9, v213
    v_mul_f32 v214, v9, v214
    v_mul_f32 v215, v9, v215
    v_cvt_pk_bf16_f32 v36, v208, v209
    v_cvt_pk_bf16_f32 v37, v210, v211
    v_cvt_pk_bf16_f32 v38, v212, v213
    v_cvt_pk_bf16_f32 v39, v214, v215
    v_cndmask_b32 v38, 0, v38, vcc
    v_cndmask_b32 v39, 0, v39, vcc
    buffer_store_dwordx4 v[36:39], v4, s[28:31], s41 offen offset:1024 sc1
    s_waitcnt vmcnt(0)
    s_mov_b64 exec, 1
    buffer_store_dword v10, v11, s[28:31], s42 offen sc1
    s_mov_b64 exec, -1
    s_endpgm
L_AUX:
    s_setprio 3
    s_add_u32 s59, s49, 7
    s_sub_u32 s27, s49, 14
    s_cmp_ge_u32 s49, 14
    s_cselect_b32 s59, s27, s59
    s_lshl_b32 s69, s59, 7
    s_mul_i32 s27, s55, 56
    v_min_u32 v16, 55, v1
    v_add_u32 v16, s27, v16
    v_mul_u32_u24 v17, 2688, v16
    s_add_u32 s60, s49, 2
    s_sub_u32 s27, s49, 5
    s_cmp_lt_u32 s49, 5
    s_cselect_b32 s60, s60, s27
    s_add_u32 s61, s57, 11
    v_lshlrev_b32 v12, 2, v1
    s_waitcnt lgkmcnt(0)
    s_mov_b32 s32, s6
    s_mov_b32 s33, s7
    s_mov_b32 s34, 1204224
    s_mov_b32 s35, 0x20000
    s_cmp_eq_u32 s26, 0
    s_cbranch_scc0 X_WD
    buffer_load_dword v17, v17, s[32:35], s69 offen
X_WD:
    s_mov_b32 s36, s12
    s_mov_b32 s37, s13
    s_mov_b32 s38, 1605632
    s_mov_b32 s39, 0x20000
    s_mov_b32 s28, s24
    s_mov_b32 s29, s25
    s_mov_b32 s30, 15876224
    s_mov_b32 s31, 0x20000
    s_lshl_b32 s27, s2, 3
    s_add_u32 s27, s27, s3
    s_cmp_eq_u32 s27, 7
    s_cbranch_scc0 X_NOEP
    s_mov_b32 s40, s22
    s_mov_b32 s41, s23
    s_mov_b32 s42, 256
    s_mov_b32 s43, 0x20000
    v_mov_b32 v20, 15876096
    v_mov_b32 v22, 0
    s_mov_b64 exec, 1
    buffer_load_dword v21, v20, s[28:31], 0 offen sc1
    s_waitcnt vmcnt(0)
    v_add_u32 v21, 1, v21
    v_max_u32 v21, 1, v21
    buffer_store_dword v21, v22, s[40:43], 0 offen sc1
    buffer_store_dword v21, v20, s[28:31], 0 offen sc1
    s_mov_b64 exec, -1
X_NOEP:
    s_cmp_eq_u32 s3, 5
    s_cbranch_scc0 X_PRE
    s_mov_b32 s40, s14
    s_mov_b32 s41, s15
    s_mov_b32 s42, 3584
    s_mov_b32 s43, 0x20000
    s_mov_b32 exec_hi, 0
    s_mov_b32 m0, 159872
    s_lshl_b32 s27, s60, 7
    buffer_load_dword v12, s[40:43], s27 offen lds
    s_mov_b32 m0, 160000
    s_lshl_b32 s27, s61, 7
    buffer_load_dword v12, s[40:43], s27 offen lds
    s_mov_b32 m0, 160128
    s_lshl_b32 s27, s51, 6
    s_add_u32 s27, s27, 3456
    buffer_load_dword v12, s[40:43], s27 offen lds
    s_mov_b32 exec_hi, -1
    v_add_u32 v20, 161536, v12
    v_mov_b32 v21, 0
    ds_write_b32 v20, v21
X_PRE:
    s_setprio 0
    v_bfe_u32 v15, v1, 2, 3
    v_lshlrev_b32 v13, 6, v3
    v_and_b32 v14, 3, v1
    v_lshl_add_u32 v13, v14, 4, v13
    v_mul_u32_u24 v4, 2688, v15
    v_add_u32 v4, v4, v13
    v_mul_u32_u24 v8, 3584, v15
    v_add_u32 v8, v8, v13
    v_add_u32 v5, 20480, v4
    v_add_u32 v9, 27648, v8
    v_add_u32 v6, 40960, v4
    v_add_u32 v10, 55296, v8
    v_add_u32 v7, 61440, v4
    v_add_u32 v11, 82944, v8
    s_mul_i32 s27, s58, 14592
    s_add_u32 s27, s27, 14942208
    s_lshl_b32 s62, s59, 8
    s_add_u32 s62, s62, s27
    s_lshl_b32 s64, s61, 8
    s_add_u32 s64, s64, s27
    s_add_u32 s64, s64, 5376
    s_lshl_b32 s63, s60, 8
    s_add_u32 s63, s63, s27
    s_add_u32 s27, s63, 5376
    s_cmp_lt_u32 s49, 5
    s_cselect_b32 s63, s63, s27
    s_mul_i32 s66, s26, 150528
    s_mul_i32 s67, s26, 200704
    s_mul_i32 s68, s26, 7168
    v_lshlrev_b32 v13, 4, v1
    v_lshlrev_b32 v14, 3, v1
    s_mul_i32 s76, s58, 28672
    s_mul_i32 s77, s58, 147456
    s_add_u32 s77, s77, 5505024
    s_add_u32 s78, s76, 3670016
    s_lshl_b32 s72, s59, 12
    s_add_u32 s27, s72, 1806336
    s_cmp_ge_u32 s59, 7
    s_cselect_b32 s72, s27, s72
    s_add_u32 s72, s72, s76
    s_sub_u32 s27, s59, 14
    s_lshl_b32 s27, s27, 10
    s_add_u32 s27, s27, s78
    s_cmp_ge_u32 s59, 14
    s_cselect_b32 s72, s27, s72
    s_lshl_b32 s74, s61, 12
    s_add_u32 s74, s74, s77
    s_lshl_b32 s73, s60, 12
    s_cmp_lt_u32 s49, 5
    s_cselect_b32 s27, s76, s77
    s_add_u32 s73, s73, s27
    v_mul_u32_u24 v15, 448, v3
    v_lshl_add_u32 v15, v2, 4, v15
    s_movk_i32 s79, 1344
    s_lshl_b32 s27, s26, 13
    v_add_u32 v57, s27, v12
    v_add_u32 v56, 4096, v57
    v_mov_b32 v59, 0
    s_mov_b32 s84, s18
    s_mov_b32 s85, s19
    s_mov_b32 s86, 896
    s_mov_b32 s87, 0x20000
    s_mov_b32 s40, s22
    s_mov_b32 s41, s23
    s_mov_b32 s42, 256
    s_mov_b32 s43, 0x20000
    s_mov_b32 s6, 1835008
    s_mov_b32 s7, 0x20000
    s_lshl_b32 s88, s52, 2
    s_and_b32 s27, s53, 3
    s_add_u32 s88, s88, s27
    s_lshr_b32 s89, s53, 2
    s_and_b32 s90, s26, 1
    s_lshr_b32 s91, s26, 1
    s_lshl_b32 s27, s88, 1
    s_add_u32 s44, s27, s90
    s_xor_b32 s45, s44, 1
    s_lshl_b32 s89, s89, 7
    s_lshl_b32 s101, s91, 6
    s_add_u32 s101, s101, s89
    s_mul_i32 s15, s44, 28672
    s_add_u32 s15, s15, s101
    v_lshlrev_b32 v39, 4, v3
    v_mul_u32_u24 v44, 896, v2
    v_add_u32 v44, v44, v39
    s_mov_b32 s10, 401408
    s_mov_b32 s11, 0x20000
    s_mov_b32 s18, 1605632
    s_mov_b32 s19, 0x20000
    s_mov_b32 s22, 1835008
    s_mov_b32 s23, 0x20000
    v_bfe_u32 v46, v1, 2, 2
    v_bfe_u32 v47, v1, 4, 1
    v_lshl_add_u32 v46, v47, 3, v46
    v_mul_u32_u24 v32, 896, v46
    v_lshl_add_u32 v32, v3, 6, v32
    v_and_b32 v46, 3, v1
    v_lshl_add_u32 v32, v46, 4, v32
    v_add_u32 v33, 2560, v32
    s_mul_i32 s88, s88, 29184
    s_add_u32 s88, s88, 14942208
    v_mov_b32 v46, 2253664544
    v_mov_b32 v47, 14465402
    v_and_b32 v45, 30, v1
    v_lshlrev_b32 v45, 1, v45
    v_lshrrev_b64 v[46:47], v45, v[46:47]
    v_bfe_u32 v47, v46, 1, 3
    v_and_b32 v46, 1, v46
    v_lshl_add_u32 v47, v47, 3, v46
    v_and_b32 v46, 1, v1
    v_mul_u32_u24 v46, 114, v46
    s_lshl_b32 s27, s26, 1
    s_add_u32 s27, s27, 42
    v_add3_u32 v47, v47, v46, s27
    v_lshlrev_b32 v47, 7, v47
    v_add_u32 v36, s88, v47
    v_bfe_u32 v47, v1, 1, 2
    v_add_u32 v46, v46, v47
    s_lshl_b32 s27, s26, 2
    s_add_u32 s27, s27, 98
    v_add_u32 v46, s27, v46
    v_lshlrev_b32 v46, 7, v46
    v_add_u32 v37, s88, v46
    s_mul_i32 s12, s26, 57344
    s_add_u32 s12, s12, s89
    s_mul_i32 s13, s26, 100352
    s_add_u32 s13, s13, s89
    s_cmp_eq_u32 s50, 7
    s_cselect_b32 s12, 0x40000000, s12
    s_cselect_b32 s15, 0x40000000, s15
    s_lshl_b32 s65, s26, 13
    s_add_u32 s14, s65, 81920
    s_mul_i32 s44, s44, 147456
    s_mul_i32 s45, s45, 147456
    s_lshl_b32 s27, s26, 13
    s_add_u32 s27, s27, 5619712
    s_add_u32 s46, s44, s27
    s_add_u32 s100, s45, s27
    s_lshl_b32 s27, s26, 12
    s_add_u32 s27, s27, 5505024
    s_add_u32 s44, s44, s27
    s_add_u32 s45, s45, s27
    v_and_b32 v46, 1, v1
    v_bfe_u32 v47, v1, 1, 1
    v_lshl_add_u32 v46, v46, 1, v47
    v_bfe_u32 v47, v1, 4, 1
    v_lshl_add_u32 v46, v47, 2, v46
    v_bfe_u32 v47, v1, 2, 2
    v_lshlrev_b32 v47, 6, v47
    v_lshl_add_u32 v46, v46, 3, v47
    v_lshl_add_u32 v46, v3, 10, v46
    s_lshl_b32 s27, s91, 9
    s_add_u32 s27, s27, s14
    v_add_u32 v34, s27, v46
    v_xor_b32 v35, 512, v34
    v_add_u32 v38, s14, v13
    s_xor_b32 s27, s26, 1
    s_lshl_b32 s27, s27, 13
    s_add_u32 s27, s27, 81920
    v_add_u32 v45, s27, v13
    s_xor_b32 s27, s26, 2
    s_lshl_b32 s27, s27, 13
    s_add_u32 s27, s27, 81920
    v_add_u32 v46, s27, v13
    s_xor_b32 s27, s26, 3
    s_lshl_b32 s27, s27, 13
    s_add_u32 s27, s27, 81920
    v_add_u32 v47, s27, v13
    s_lshl_b32 s69, s59, 7
    s_add_u32 s70, s69, 602112
    s_lshl_b32 s71, s60, 7
    s_waitcnt lgkmcnt(0)
    s_barrier
    s_add_u32 m0, s68, 118784
    s_add_u32 s27, s69, s66
    buffer_load_dwordx4 v4, s[32:35], s27 offen offset:0 lds
    buffer_load_dwordx4 v5, s[32:35], s27 offen offset:1024 lds
    buffer_load_dwordx4 v6, s[32:35], s27 offen offset:2048 lds
    buffer_load_dwordx4 v7, s[32:35], s27 offen offset:3072 lds
    s_add_u32 m0, m0, 4096
    s_add_u32 s27, s27, 86016
    buffer_load_dwordx4 v4, s[32:35], s27 offen offset:0 lds
    buffer_load_dwordx4 v5, s[32:35], s27 offen offset:1024 lds
    buffer_load_dwordx4 v6, s[32:35], s27 offen offset:2048 lds
    s_add_u32 m0, s68, 90112
    s_add_u32 s27, s70, s66
    buffer_load_dwordx4 v4, s[32:35], s27 offen offset:0 lds
    buffer_load_dwordx4 v5, s[32:35], s27 offen offset:1024 lds
    buffer_load_dwordx4 v6, s[32:35], s27 offen offset:2048 lds
    buffer_load_dwordx4 v7, s[32:35], s27 offen offset:3072 lds
    s_add_u32 m0, m0, 4096
    s_add_u32 s27, s27, 86016
    buffer_load_dwordx4 v4, s[32:35], s27 offen offset:0 lds
    buffer_load_dwordx4 v5, s[32:35], s27 offen offset:1024 lds
    buffer_load_dwordx4 v6, s[32:35], s27 offen offset:2048 lds
    s_cmp_lt_u32 s49, 5
    s_cbranch_scc0 X_D2F
    s_add_u32 s83, s71, 0
    s_add_u32 m0, s68, 32768
    s_add_u32 s27, s83, s66
    buffer_load_dwordx4 v4, s[32:35], s27 offen offset:0 lds
    buffer_load_dwordx4 v5, s[32:35], s27 offen offset:1024 lds
    buffer_load_dwordx4 v6, s[32:35], s27 offen offset:2048 lds
    buffer_load_dwordx4 v7, s[32:35], s27 offen offset:3072 lds
    s_add_u32 m0, m0, 4096
    s_add_u32 s27, s27, 86016
    buffer_load_dwordx4 v4, s[32:35], s27 offen offset:0 lds
    buffer_load_dwordx4 v5, s[32:35], s27 offen offset:1024 lds
    buffer_load_dwordx4 v6, s[32:35], s27 offen offset:2048 lds
    s_branch X_D2D
X_D2F:
    s_add_u32 s83, s71, 0
    s_add_u32 m0, s68, 32768
    s_add_u32 s27, s83, s67
    buffer_load_dwordx4 v8, s[36:39], s27 offen offset:0 lds
    buffer_load_dwordx4 v9, s[36:39], s27 offen offset:1024 lds
    buffer_load_dwordx4 v10, s[36:39], s27 offen offset:2048 lds
    buffer_load_dwordx4 v11, s[36:39], s27 offen offset:3072 lds
    s_add_u32 m0, m0, 4096
    s_add_u32 s27, s27, 114688
    buffer_load_dwordx4 v8, s[36:39], s27 offen offset:0 lds
    buffer_load_dwordx4 v9, s[36:39], s27 offen offset:1024 lds
    buffer_load_dwordx4 v10, s[36:39], s27 offen offset:2048 lds
X_D2D:
    buffer_load_dword v58, v59, s[40:43], 0 offen sc1
    s_waitcnt vmcnt(15)
    s_barrier
    s_lshl_b32 s27, s26, 8
    s_add_u32 s27, s27, 160512
    v_lshl_add_u32 v16, v2, 2, s27
    v_lshl_add_u32 v17, v3, 4, s27
    ds_read_b32 v40, v16
    ds_read_b32 v41, v16 offset:128
    v_mov_b32 v18, 161600
    s_waitcnt vmcnt(8)
    s_barrier
    s_cmp_lt_u32 s49, 5
    s_cbranch_scc0 X_D3F
    s_add_u32 s83, s71, 602112
    s_add_u32 m0, s68, 61440
    s_add_u32 s27, s83, s66
    buffer_load_dwordx4 v4, s[32:35], s27 offen offset:0 lds
    buffer_load_dwordx4 v5, s[32:35], s27 offen offset:1024 lds
    buffer_load_dwordx4 v6, s[32:35], s27 offen offset:2048 lds
    buffer_load_dwordx4 v7, s[32:35], s27 offen offset:3072 lds
    s_add_u32 m0, m0, 4096
    s_add_u32 s27, s27, 86016
    buffer_load_dwordx4 v4, s[32:35], s27 offen offset:0 lds
    buffer_load_dwordx4 v5, s[32:35], s27 offen offset:1024 lds
    buffer_load_dwordx4 v6, s[32:35], s27 offen offset:2048 lds
    s_branch X_D3D
X_D3F:
    s_add_u32 s83, s71, 802816
    s_add_u32 m0, s68, 61440
    s_add_u32 s27, s83, s67
    buffer_load_dwordx4 v8, s[36:39], s27 offen offset:0 lds
    buffer_load_dwordx4 v9, s[36:39], s27 offen offset:1024 lds
    buffer_load_dwordx4 v10, s[36:39], s27 offen offset:2048 lds
    buffer_load_dwordx4 v11, s[36:39], s27 offen offset:3072 lds
    s_add_u32 m0, m0, 4096
    s_add_u32 s27, s27, 114688
    buffer_load_dwordx4 v8, s[36:39], s27 offen offset:0 lds
    buffer_load_dwordx4 v9, s[36:39], s27 offen offset:1024 lds
    buffer_load_dwordx4 v10, s[36:39], s27 offen offset:2048 lds
X_D3D:
    v_mov_b32 v7, v17
    buffer_load_dwordx4 v[80:83], v44, s[4:7], s15 offen
    buffer_load_dwordx4 v[84:87], v44, s[4:7], s15 offen offset:32
    buffer_load_dwordx4 v[88:91], v39, s[84:87], s101 offen
    buffer_load_dwordx4 v[92:95], v39, s[84:87], s101 offen offset:32
    s_cmp_ge_u32 s49, 14
    s_cselect_b32 s27, 0x3e8b97f6, 1.0
    s_waitcnt lgkmcnt(0)
    v_mul_f32 v42, 0xc0135761, v40
    v_mul_f32 v43, v40, v40
    v_mul_f32 v43, v43, v40
    v_mul_f32 v43, 0xbdd2d3e8, v43
    v_mul_f32 v40, s27, v40
    s_add_u32 s27, s12, 0
    buffer_load_dwordx4 v[96:99], v32, s[16:19], s27 offen
    buffer_load_dwordx4 v[100:103], v33, s[16:19], s27 offen offset:1024
    s_add_u32 s27, s12, 14336
    buffer_load_dwordx4 v[104:107], v32, s[16:19], s27 offen
    buffer_load_dwordx4 v[108:111], v33, s[16:19], s27 offen offset:1024
    s_mov_b32 s27, 65536
    s_waitcnt vmcnt(15)
    s_branch X_EP_L
X_EP:
    s_sleep 3
    buffer_load_dword v58, v59, s[40:43], 0 offen sc1
    s_waitcnt vmcnt(0)
X_EP_L:
    v_readfirstlane_b32 s47, v58
    s_sub_u32 s27, s27, 1
    s_cbranch_scc1 X_EP_X
    s_cmp_eq_u32 s47, 0
    s_cbranch_scc1 X_EP
X_EP_X:
    ds_write_b32 v18, v58
    s_lshl_b32 s82, s61, 7
    s_waitcnt lgkmcnt(0)
    s_barrier
    ds_read2st64_b32 v[64:65], v56 offset0:0 offset1:1
    ds_read2st64_b32 v[66:67], v56 offset0:2 offset1:3
    ds_read2st64_b32 v[68:69], v56 offset0:4 offset1:5
    ds_read2st64_b32 v[70:71], v56 offset0:6 offset1:7
    ds_read2st64_b32 v[72:73], v56 offset0:8 offset1:9
    ds_read2st64_b32 v[74:75], v56 offset0:10 offset1:11
    ds_read2st64_b32 v[76:77], v56 offset0:12 offset1:13
    ds_read2st64_b32 v[78:79], v56 offset0:14 offset1:15
    s_bitcmp1_b32 s54, 0
    s_cbranch_scc1 X_B0
    s_call_b64 s[90:91], X_QK0
    s_branch X_C0
X_B0:
    s_call_b64 s[90:91], X_V0
X_C0:
    s_add_u32 m0, s68, 118784
    s_add_u32 s27, s82, s67
    buffer_load_dwordx4 v8, s[36:39], s27 offen offset:0 lds
    buffer_load_dwordx4 v9, s[36:39], s27 offen offset:1024 lds
    buffer_load_dwordx4 v10, s[36:39], s27 offen offset:2048 lds
    buffer_load_dwordx4 v11, s[36:39], s27 offen offset:3072 lds
    s_add_u32 m0, m0, 4096
    s_add_u32 s27, s27, 114688
    buffer_load_dwordx4 v8, s[36:39], s27 offen offset:0 lds
    buffer_load_dwordx4 v9, s[36:39], s27 offen offset:1024 lds
    buffer_load_dwordx4 v10, s[36:39], s27 offen offset:2048 lds
    s_add_u32 s27, s12, 229376
    buffer_load_dwordx4 v[112:115], v32, s[16:19], s27 offen
    buffer_load_dwordx4 v[116:119], v33, s[16:19], s27 offen offset:1024
    s_waitcnt vmcnt(19)
    s_barrier
    ds_read2st64_b32 v[128:129], v57 offset0:0 offset1:1
    ds_read2st64_b32 v[130:131], v57 offset0:2 offset1:3
    ds_read2st64_b32 v[132:133], v57 offset0:4 offset1:5
    ds_read2st64_b32 v[134:135], v57 offset0:6 offset1:7
    ds_read2st64_b32 v[136:137], v57 offset0:8 offset1:9
    ds_read2st64_b32 v[138:139], v57 offset0:10 offset1:11
    ds_read2st64_b32 v[140:141], v57 offset0:12 offset1:13
    ds_read2st64_b32 v[142:143], v57 offset0:14 offset1:15
    s_bitcmp1_b32 s54, 2
    s_cbranch_scc1 X_B1
    s_call_b64 s[90:91], X_QK1
    s_branch X_C1
X_B1:
    s_call_b64 s[90:91], X_V1
X_C1:
    s_mov_b32 s72, s73
    s_add_u32 s82, s82, 802816
    s_add_u32 m0, s68, 90112
    s_add_u32 s27, s82, s67
    buffer_load_dwordx4 v8, s[36:39], s27 offen offset:0 lds
    buffer_load_dwordx4 v9, s[36:39], s27 offen offset:1024 lds
    buffer_load_dwordx4 v10, s[36:39], s27 offen offset:2048 lds
    buffer_load_dwordx4 v11, s[36:39], s27 offen offset:3072 lds
    s_add_u32 m0, m0, 4096
    s_add_u32 s27, s27, 114688
    buffer_load_dwordx4 v8, s[36:39], s27 offen offset:0 lds
    buffer_load_dwordx4 v9, s[36:39], s27 offen offset:1024 lds
    buffer_load_dwordx4 v10, s[36:39], s27 offen offset:2048 lds
    s_add_u32 s27, s12, 243712
    buffer_load_dwordx4 v[120:123], v32, s[16:19], s27 offen
    buffer_load_dwordx4 v[124:127], v33, s[16:19], s27 offen offset:1024
    s_waitcnt vmcnt(13)
    s_barrier
    ds_read2st64_b32 v[64:65], v56 offset0:0 offset1:1
    ds_read2st64_b32 v[66:67], v56 offset0:2 offset1:3
    ds_read2st64_b32 v[68:69], v56 offset0:4 offset1:5
    ds_read2st64_b32 v[70:71], v56 offset0:6 offset1:7
    ds_read2st64_b32 v[72:73], v56 offset0:8 offset1:9
    ds_read2st64_b32 v[74:75], v56 offset0:10 offset1:11
    ds_read2st64_b32 v[76:77], v56 offset0:12 offset1:13
    ds_read2st64_b32 v[78:79], v56 offset0:14 offset1:15
    s_cmp_lt_u32 s49, 5
    s_cbranch_scc0 X_R1F
    s_waitcnt vmcnt(0)
    s_mov_b64 exec, 1
    buffer_store_dword v58, v59, s[28:31], s62 offen offset:0 sc1
    s_mov_b64 exec, -1
    s_mov_b64 exec, 1
    buffer_store_dword v58, v59, s[28:31], s62 offen offset:128 sc1
    s_mov_b64 exec, -1
    v_mul_f32 v40, 0x3e8b97f6, v40
    s_call_b64 s[90:91], X_QK0
    s_add_u32 s27, s12, 688128
    buffer_load_dwordx4 v[192:195], v32, s[16:19], s27 offen
    buffer_load_dwordx4 v[196:199], v33, s[16:19], s27 offen offset:1024
    s_add_u32 s27, s12, 702464
    buffer_load_dwordx4 v[200:203], v32, s[16:19], s27 offen
    buffer_load_dwordx4 v[204:207], v33, s[16:19], s27 offen offset:1024
    s_add_u32 s27, s12, 917504
    buffer_load_dwordx4 v[208:211], v32, s[16:19], s27 offen
    buffer_load_dwordx4 v[212:215], v33, s[16:19], s27 offen offset:1024
    s_add_u32 s27, s12, 931840
    buffer_load_dwordx4 v[216:219], v32, s[16:19], s27 offen
    buffer_load_dwordx4 v[220:223], v33, s[16:19], s27 offen offset:1024
    s_barrier
    ds_read2st64_b32 v[128:129], v57 offset0:0 offset1:1
    ds_read2st64_b32 v[130:131], v57 offset0:2 offset1:3
    ds_read2st64_b32 v[132:133], v57 offset0:4 offset1:5
    ds_read2st64_b32 v[134:135], v57 offset0:6 offset1:7
    ds_read2st64_b32 v[136:137], v57 offset0:8 offset1:9
    ds_read2st64_b32 v[138:139], v57 offset0:10 offset1:11
    ds_read2st64_b32 v[140:141], v57 offset0:12 offset1:13
    ds_read2st64_b32 v[142:143], v57 offset0:14 offset1:15
    s_waitcnt vmcnt(0)
    s_mov_b64 exec, 1
    buffer_store_dword v58, v59, s[28:31], s63 offen offset:0 sc1
    s_mov_b64 exec, -1
    s_call_b64 s[90:91], X_QK1
    s_waitcnt vmcnt(0)
    s_mov_b64 exec, 1
    buffer_store_dword v58, v59, s[28:31], s63 offen offset:128 sc1
    s_mov_b64 exec, -1
    s_barrier
    ds_read2st64_b32 v[64:65], v56 offset0:0 offset1:1
    ds_read2st64_b32 v[66:67], v56 offset0:2 offset1:3
    ds_read2st64_b32 v[68:69], v56 offset0:4 offset1:5
    ds_read2st64_b32 v[70:71], v56 offset0:6 offset1:7
    ds_read2st64_b32 v[72:73], v56 offset0:8 offset1:9
    ds_read2st64_b32 v[74:75], v56 offset0:10 offset1:11
    ds_read2st64_b32 v[76:77], v56 offset0:12 offset1:13
    ds_read2st64_b32 v[78:79], v56 offset0:14 offset1:15
    s_add_u32 s27, s12, 1146880
    buffer_load_dwordx4 v[224:227], v32, s[16:19], s27 offen
    buffer_load_dwordx4 v[228:231], v33, s[16:19], s27 offen offset:1024
    s_add_u32 s27, s12, 1161216
    buffer_load_dwordx4 v[232:235], v32, s[16:19], s27 offen
    buffer_load_dwordx4 v[236:239], v33, s[16:19], s27 offen offset:1024
    s_add_u32 s27, s12, 716800
    buffer_load_dwordx4 v[240:243], v32, s[16:19], s27 offen
    buffer_load_dwordx4 v[244:247], v33, s[16:19], s27 offen offset:1024
    s_add_u32 s27, s12, 731136
    buffer_load_dwordx4 v[248:251], v32, s[16:19], s27 offen
    buffer_load_dwordx4 v[252:255], v33, s[16:19], s27 offen offset:1024
    s_branch X_R2
X_R1F:
    s_waitcnt lgkmcnt(6)
    v_mul_f32 v16, v64, v64
    v_mul_f32 v17, v65, v65
    v_mul_f32 v18, v66, v66
    v_mul_f32 v19, v67, v67
    v_fma_f32 v16, v16, v43, v42
    v_fma_f32 v17, v17, v43, v42
    v_fma_f32 v18, v18, v43, v42
    v_fma_f32 v19, v19, v43, v42
    v_mul_f32 v16, v64, v16
    v_mul_f32 v17, v65, v17
    v_mul_f32 v18, v66, v18
    v_mul_f32 v19, v67, v19
    v_exp_f32 v16, v16
    v_exp_f32 v17, v17
    v_exp_f32 v18, v18
    v_exp_f32 v19, v19
    v_fma_f32 v16, v16, v41, v41
    v_fma_f32 v17, v17, v41, v41
    v_fma_f32 v18, v18, v41, v41
    v_fma_f32 v19, v19, v41, v41
    v_rcp_f32 v16, v16
    v_rcp_f32 v17, v17
    v_rcp_f32 v18, v18
    v_rcp_f32 v19, v19
    v_mul_f32 v16, v64, v16
    v_mul_f32 v17, v65, v17
    v_mul_f32 v18, v66, v18
    v_mul_f32 v19, v67, v19
    v_cvt_pk_bf16_f32 v48, v16, v17
    v_cvt_pk_bf16_f32 v49, v18, v19
    s_waitcnt lgkmcnt(4)
    v_mul_f32 v20, v68, v68
    v_mul_f32 v21, v69, v69
    v_mul_f32 v22, v70, v70
    v_mul_f32 v23, v71, v71
    v_fma_f32 v20, v20, v43, v42
    v_fma_f32 v21, v21, v43, v42
    v_fma_f32 v22, v22, v43, v42
    v_fma_f32 v23, v23, v43, v42
    v_mul_f32 v20, v68, v20
    v_mul_f32 v21, v69, v21
    v_mul_f32 v22, v70, v22
    v_mul_f32 v23, v71, v23
    v_exp_f32 v20, v20
    v_exp_f32 v21, v21
    v_exp_f32 v22, v22
    v_exp_f32 v23, v23
    v_fma_f32 v20, v20, v41, v41
    v_fma_f32 v21, v21, v41, v41
    v_fma_f32 v22, v22, v41, v41
    v_fma_f32 v23, v23, v41, v41
    v_rcp_f32 v20, v20
    v_rcp_f32 v21, v21
    v_rcp_f32 v22, v22
    v_rcp_f32 v23, v23
    v_mul_f32 v20, v68, v20
    v_mul_f32 v21, v69, v21
    v_mul_f32 v22, v70, v22
    v_mul_f32 v23, v71, v23
    v_cvt_pk_bf16_f32 v50, v20, v21
    v_cvt_pk_bf16_f32 v51, v22, v23
    s_waitcnt vmcnt(0)
    s_mov_b64 exec, 1
    buffer_store_dword v58, v59, s[28:31], s62 offen offset:0 sc1
    s_mov_b64 exec, -1
    s_mov_b64 exec, 1
    buffer_store_dword v58, v59, s[28:31], s62 offen offset:128 sc1
    s_mov_b64 exec, -1
    s_cmp_eq_u32 s50, 7
    s_cbranch_scc0 X_N6
    v_mul_u32_u24 v60, 802752, v3
    v_add_u32 v8, v60, v8
    v_add_u32 v9, v60, v9
    v_add_u32 v10, v60, v10
    v_add_u32 v11, v60, v11
    s_lshl_b32 s82, s51, 6
    s_add_u32 s82, s82, 3456
    s_add_u32 m0, s68, 32768
    s_add_u32 s27, s82, s67
    buffer_load_dwordx4 v8, s[36:39], s27 offen offset:0 lds
    buffer_load_dwordx4 v9, s[36:39], s27 offen offset:1024 lds
    buffer_load_dwordx4 v10, s[36:39], s27 offen offset:2048 lds
    buffer_load_dwordx4 v11, s[36:39], s27 offen offset:3072 lds
    s_add_u32 m0, m0, 4096
    s_add_u32 s27, s27, 114688
    buffer_load_dwordx4 v8, s[36:39], s27 offen offset:0 lds
    buffer_load_dwordx4 v9, s[36:39], s27 offen offset:1024 lds
    buffer_load_dwordx4 v10, s[36:39], s27 offen offset:2048 lds
    X_N6:
    buffer_store_dwordx4 v[48:51], v13, s[28:31], s72 offen offset:0 sc1
    s_add_u32 s27, s12, 688128
    buffer_load_dwordx4 v[192:195], v32, s[16:19], s27 offen
    s_waitcnt lgkmcnt(2)
    v_mul_f32 v16, v72, v72
    v_mul_f32 v17, v73, v73
    v_mul_f32 v18, v74, v74
    v_mul_f32 v19, v75, v75
    buffer_load_dwordx4 v[196:199], v33, s[16:19], s27 offen offset:1024
    v_fma_f32 v16, v16, v43, v42
    v_fma_f32 v17, v17, v43, v42
    v_fma_f32 v18, v18, v43, v42
    v_fma_f32 v19, v19, v43, v42
    v_mul_f32 v16, v72, v16
    v_mul_f32 v17, v73, v17
    v_mul_f32 v18, v74, v18
    v_mul_f32 v19, v75, v19
    s_add_u32 s27, s12, 702464
    buffer_load_dwordx4 v[200:203], v32, s[16:19], s27 offen
    v_exp_f32 v16, v16
    v_exp_f32 v17, v17
    v_exp_f32 v18, v18
    v_exp_f32 v19, v19
    buffer_load_dwordx4 v[204:207], v33, s[16:19], s27 offen offset:1024
    v_fma_f32 v16, v16, v41, v41
    v_fma_f32 v17, v17, v41, v41
    v_fma_f32 v18, v18, v41, v41
    v_fma_f32 v19, v19, v41, v41
    v_rcp_f32 v16, v16
    v_rcp_f32 v17, v17
    s_add_u32 s27, s12, 917504
    buffer_load_dwordx4 v[208:211], v32, s[16:19], s27 offen
    v_rcp_f32 v18, v18
    v_rcp_f32 v19, v19
    v_mul_f32 v16, v72, v16
    v_mul_f32 v17, v73, v17
    v_mul_f32 v18, v74, v18
    v_mul_f32 v19, v75, v19
    v_cvt_pk_bf16_f32 v52, v16, v17
    v_cvt_pk_bf16_f32 v53, v18, v19
    buffer_load_dwordx4 v[212:215], v33, s[16:19], s27 offen offset:1024
    s_waitcnt lgkmcnt(0)
    v_mul_f32 v20, v76, v76
    v_mul_f32 v21, v77, v77
    v_mul_f32 v22, v78, v78
    v_mul_f32 v23, v79, v79
    s_add_u32 s27, s12, 931840
    buffer_load_dwordx4 v[216:219], v32, s[16:19], s27 offen
    s_waitcnt lgkmcnt(0)
    s_barrier
    ds_read2st64_b32 v[128:129], v57 offset0:0 offset1:1
    ds_read2st64_b32 v[130:131], v57 offset0:2 offset1:3
    ds_read2st64_b32 v[132:133], v57 offset0:4 offset1:5
    ds_read2st64_b32 v[134:135], v57 offset0:6 offset1:7
    ds_read2st64_b32 v[136:137], v57 offset0:8 offset1:9
    ds_read2st64_b32 v[138:139], v57 offset0:10 offset1:11
    ds_read2st64_b32 v[140:141], v57 offset0:12 offset1:13
    ds_read2st64_b32 v[142:143], v57 offset0:14 offset1:15
    v_fma_f32 v20, v20, v43, v42
    v_fma_f32 v21, v21, v43, v42
    v_fma_f32 v22, v22, v43, v42
    v_fma_f32 v23, v23, v43, v42
    v_mul_f32 v20, v76, v20
    v_mul_f32 v21, v77, v21
    v_mul_f32 v22, v78, v22
    v_mul_f32 v23, v79, v23
    buffer_load_dwordx4 v[220:223], v33, s[16:19], s27 offen offset:1024
    v_exp_f32 v20, v20
    v_exp_f32 v21, v21
    v_exp_f32 v22, v22
    v_exp_f32 v23, v23
    v_fma_f32 v20, v20, v41, v41
    v_fma_f32 v21, v21, v41, v41
    v_fma_f32 v22, v22, v41, v41
    v_fma_f32 v23, v23, v41, v41
    v_rcp_f32 v20, v20
    v_rcp_f32 v21, v21
    v_rcp_f32 v22, v22
    v_rcp_f32 v23, v23
    v_mul_f32 v20, v76, v20
    v_mul_f32 v21, v77, v21
    v_mul_f32 v22, v78, v22
    v_mul_f32 v23, v79, v23
    v_cvt_pk_bf16_f32 v54, v20, v21
    v_cvt_pk_bf16_f32 v55, v22, v23
    buffer_store_dwordx4 v[52:55], v13, s[28:31], s72 offen offset:1024 sc1
    s_add_u32 s72, s72, 2048
    s_waitcnt lgkmcnt(6)
    v_mul_f32 v16, v128, v128
    v_mul_f32 v17, v129, v129
    v_mul_f32 v18, v130, v130
    v_mul_f32 v19, v131, v131
    v_fma_f32 v16, v16, v43, v42
    v_fma_f32 v17, v17, v43, v42
    v_fma_f32 v18, v18, v43, v42
    v_fma_f32 v19, v19, v43, v42
    v_mul_f32 v16, v128, v16
    v_mul_f32 v17, v129, v17
    v_mul_f32 v18, v130, v18
    v_mul_f32 v19, v131, v19
    v_exp_f32 v16, v16
    v_exp_f32 v17, v17
    v_exp_f32 v18, v18
    v_exp_f32 v19, v19
    v_fma_f32 v16, v16, v41, v41
    v_fma_f32 v17, v17, v41, v41
    v_fma_f32 v18, v18, v41, v41
    v_fma_f32 v19, v19, v41, v41
    v_rcp_f32 v16, v16
    v_rcp_f32 v17, v17
    v_rcp_f32 v18, v18
    v_rcp_f32 v19, v19
    v_mul_f32 v16, v128, v16
    v_mul_f32 v17, v129, v17
    v_mul_f32 v18, v130, v18
    v_mul_f32 v19, v131, v19
    v_cvt_pk_bf16_f32 v48, v16, v17
    v_cvt_pk_bf16_f32 v49, v18, v19
    s_waitcnt lgkmcnt(4)
    v_mul_f32 v20, v132, v132
    v_mul_f32 v21, v133, v133
    v_mul_f32 v22, v134, v134
    v_mul_f32 v23, v135, v135
    v_fma_f32 v20, v20, v43, v42
    v_fma_f32 v21, v21, v43, v42
    v_fma_f32 v22, v22, v43, v42
    v_fma_f32 v23, v23, v43, v42
    v_mul_f32 v20, v132, v20
    v_mul_f32 v21, v133, v21
    v_mul_f32 v22, v134, v22
    v_mul_f32 v23, v135, v23
    v_exp_f32 v20, v20
    v_exp_f32 v21, v21
    v_exp_f32 v22, v22
    v_exp_f32 v23, v23
    v_fma_f32 v20, v20, v41, v41
    v_fma_f32 v21, v21, v41, v41
    v_fma_f32 v22, v22, v41, v41
    v_fma_f32 v23, v23, v41, v41
    v_rcp_f32 v20, v20
    v_rcp_f32 v21, v21
    v_rcp_f32 v22, v22
    v_rcp_f32 v23, v23
    v_mul_f32 v20, v132, v20
    v_mul_f32 v21, v133, v21
    v_mul_f32 v22, v134, v22
    v_mul_f32 v23, v135, v23
    v_cvt_pk_bf16_f32 v50, v20, v21
    v_cvt_pk_bf16_f32 v51, v22, v23
    s_waitcnt vmcnt(0)
    s_mov_b64 exec, 1
    buffer_store_dword v58, v59, s[28:31], s63 offen offset:0 sc1
    s_mov_b64 exec, -1
    buffer_store_dwordx4 v[48:51], v13, s[28:31], s72 offen offset:0 sc1
    s_add_u32 s27, s12, 1146880
    buffer_load_dwordx4 v[224:227], v32, s[16:19], s27 offen
    s_waitcnt lgkmcnt(2)
    v_mul_f32 v16, v136, v136
    v_mul_f32 v17, v137, v137
    v_mul_f32 v18, v138, v138
    v_mul_f32 v19, v139, v139
    buffer_load_dwordx4 v[228:231], v33, s[16:19], s27 offen offset:1024
    v_fma_f32 v16, v16, v43, v42
    v_fma_f32 v17, v17, v43, v42
    v_fma_f32 v18, v18, v43, v42
    v_fma_f32 v19, v19, v43, v42
    v_mul_f32 v16, v136, v16
    v_mul_f32 v17, v137, v17
    v_mul_f32 v18, v138, v18
    v_mul_f32 v19, v139, v19
    s_add_u32 s27, s12, 1161216
    buffer_load_dwordx4 v[232:235], v32, s[16:19], s27 offen
    v_exp_f32 v16, v16
    v_exp_f32 v17, v17
    v_exp_f32 v18, v18
    v_exp_f32 v19, v19
    buffer_load_dwordx4 v[236:239], v33, s[16:19], s27 offen offset:1024
    v_fma_f32 v16, v16, v41, v41
    v_fma_f32 v17, v17, v41, v41
    v_fma_f32 v18, v18, v41, v41
    v_fma_f32 v19, v19, v41, v41
    v_rcp_f32 v16, v16
    v_rcp_f32 v17, v17
    s_add_u32 s27, s12, 716800
    buffer_load_dwordx4 v[240:243], v32, s[16:19], s27 offen
    v_rcp_f32 v18, v18
    v_rcp_f32 v19, v19
    v_mul_f32 v16, v136, v16
    v_mul_f32 v17, v137, v17
    v_mul_f32 v18, v138, v18
    v_mul_f32 v19, v139, v19
    v_cvt_pk_bf16_f32 v52, v16, v17
    v_cvt_pk_bf16_f32 v53, v18, v19
    buffer_load_dwordx4 v[244:247], v33, s[16:19], s27 offen offset:1024
    s_waitcnt lgkmcnt(0)
    v_mul_f32 v20, v140, v140
    v_mul_f32 v21, v141, v141
    v_mul_f32 v22, v142, v142
    v_mul_f32 v23, v143, v143
    s_add_u32 s27, s12, 731136
    buffer_load_dwordx4 v[248:251], v32, s[16:19], s27 offen
    s_waitcnt lgkmcnt(0)
    s_barrier
    ds_read2st64_b32 v[64:65], v56 offset0:0 offset1:1
    ds_read2st64_b32 v[66:67], v56 offset0:2 offset1:3
    ds_read2st64_b32 v[68:69], v56 offset0:4 offset1:5
    ds_read2st64_b32 v[70:71], v56 offset0:6 offset1:7
    ds_read2st64_b32 v[72:73], v56 offset0:8 offset1:9
    ds_read2st64_b32 v[74:75], v56 offset0:10 offset1:11
    ds_read2st64_b32 v[76:77], v56 offset0:12 offset1:13
    ds_read2st64_b32 v[78:79], v56 offset0:14 offset1:15
    v_fma_f32 v20, v20, v43, v42
    v_fma_f32 v21, v21, v43, v42
    v_fma_f32 v22, v22, v43, v42
    v_fma_f32 v23, v23, v43, v42
    v_mul_f32 v20, v140, v20
    v_mul_f32 v21, v141, v21
    v_mul_f32 v22, v142, v22
    v_mul_f32 v23, v143, v23
    buffer_load_dwordx4 v[252:255], v33, s[16:19], s27 offen offset:1024
    v_exp_f32 v20, v20
    v_exp_f32 v21, v21
    v_exp_f32 v22, v22
    v_exp_f32 v23, v23
    v_fma_f32 v20, v20, v41, v41
    v_fma_f32 v21, v21, v41, v41
    v_fma_f32 v22, v22, v41, v41
    v_fma_f32 v23, v23, v41, v41
    v_rcp_f32 v20, v20
    v_rcp_f32 v21, v21
    v_rcp_f32 v22, v22
    v_rcp_f32 v23, v23
    v_mul_f32 v20, v140, v20
    v_mul_f32 v21, v141, v21
    v_mul_f32 v22, v142, v22
    v_mul_f32 v23, v143, v23
    v_cvt_pk_bf16_f32 v54, v20, v21
    v_cvt_pk_bf16_f32 v55, v22, v23
    buffer_store_dwordx4 v[52:55], v13, s[28:31], s72 offen offset:1024 sc1
    s_add_u32 s72, s72, 2048
X_R2:
    s_mov_b32 s72, s74
    s_waitcnt lgkmcnt(6)
    v_mul_f32 v16, v64, v64
    v_mul_f32 v17, v65, v65
    v_mul_f32 v18, v66, v66
    v_mul_f32 v19, v67, v67
    v_fma_f32 v16, v16, v43, v42
    v_fma_f32 v17, v17, v43, v42
    v_fma_f32 v18, v18, v43, v42
    v_fma_f32 v19, v19, v43, v42
    v_mul_f32 v16, v64, v16
    v_mul_f32 v17, v65, v17
    v_mul_f32 v18, v66, v18
    v_mul_f32 v19, v67, v19
    v_exp_f32 v16, v16
    v_exp_f32 v17, v17
    v_exp_f32 v18, v18
    v_exp_f32 v19, v19
    v_fma_f32 v16, v16, v41, v41
    v_fma_f32 v17, v17, v41, v41
    v_fma_f32 v18, v18, v41, v41
    v_fma_f32 v19, v19, v41, v41
    v_rcp_f32 v16, v16
    v_rcp_f32 v17, v17
    v_rcp_f32 v18, v18
    v_rcp_f32 v19, v19
    v_mul_f32 v16, v64, v16
    v_mul_f32 v17, v65, v17
    v_mul_f32 v18, v66, v18
    v_mul_f32 v19, v67, v19
    v_cvt_pk_bf16_f32 v48, v16, v17
    v_cvt_pk_bf16_f32 v49, v18, v19
    s_waitcnt lgkmcnt(4)
    v_mul_f32 v20, v68, v68
    v_mul_f32 v21, v69, v69
    v_mul_f32 v22, v70, v70
    v_mul_f32 v23, v71, v71
    v_fma_f32 v20, v20, v43, v42
    v_fma_f32 v21, v21, v43, v42
    v_fma_f32 v22, v22, v43, v42
    v_fma_f32 v23, v23, v43, v42
    v_mul_f32 v20, v68, v20
    v_mul_f32 v21, v69, v21
    v_mul_f32 v22, v70, v22
    v_mul_f32 v23, v71, v23
    v_exp_f32 v20, v20
    v_exp_f32 v21, v21
    v_exp_f32 v22, v22
    v_exp_f32 v23, v23
    v_fma_f32 v20, v20, v41, v41
    v_fma_f32 v21, v21, v41, v41
    v_fma_f32 v22, v22, v41, v41
    v_fma_f32 v23, v23, v41, v41
    v_rcp_f32 v20, v20
    v_rcp_f32 v21, v21
    v_rcp_f32 v22, v22
    v_rcp_f32 v23, v23
    v_mul_f32 v20, v68, v20
    v_mul_f32 v21, v69, v21
    v_mul_f32 v22, v70, v22
    v_mul_f32 v23, v71, v23
    v_cvt_pk_bf16_f32 v50, v20, v21
    v_cvt_pk_bf16_f32 v51, v22, v23
    s_setprio 2
    s_waitcnt vmcnt(0)
    s_mov_b64 exec, 1
    buffer_store_dword v58, v59, s[28:31], s63 offen offset:128 sc1
    s_mov_b64 exec, -1
    s_mov_b64 exec, 0xf
    buffer_load_dword v62, v36, s[28:31], 0 offen sc1
    s_mov_b64 exec, -1
    buffer_store_dwordx4 v[48:51], v13, s[28:31], s72 offen offset:0 sc1
    s_waitcnt lgkmcnt(2)
    v_mul_f32 v16, v72, v72
    v_mul_f32 v17, v73, v73
    v_mul_f32 v18, v74, v74
    v_mul_f32 v19, v75, v75
    v_fma_f32 v16, v16, v43, v42
    v_fma_f32 v17, v17, v43, v42
    v_fma_f32 v18, v18, v43, v42
    v_fma_f32 v19, v19, v43, v42
    v_mul_f32 v16, v72, v16
    v_mul_f32 v17, v73, v17
    v_mul_f32 v18, v74, v18
    v_mul_f32 v19, v75, v19
    v_exp_f32 v16, v16
    v_exp_f32 v17, v17
    v_exp_f32 v18, v18
    v_exp_f32 v19, v19
    v_fma_f32 v16, v16, v41, v41
    v_fma_f32 v17, v17, v41, v41
    v_fma_f32 v18, v18, v41, v41
    v_fma_f32 v19, v19, v41, v41
    v_rcp_f32 v16, v16
    v_rcp_f32 v17, v17
    v_rcp_f32 v18, v18
    v_rcp_f32 v19, v19
    v_mul_f32 v16, v72, v16
    v_mul_f32 v17, v73, v17
    v_mul_f32 v18, v74, v18
    v_mul_f32 v19, v75, v19
    v_cvt_pk_bf16_f32 v52, v16, v17
    v_cvt_pk_bf16_f32 v53, v18, v19
    s_waitcnt lgkmcnt(0)
    v_mul_f32 v20, v76, v76
    v_mul_f32 v21, v77, v77
    v_mul_f32 v22, v78, v78
    v_mul_f32 v23, v79, v79
    v_fma_f32 v20, v20, v43, v42
    v_fma_f32 v21, v21, v43, v42
    v_fma_f32 v22, v22, v43, v42
    v_fma_f32 v23, v23, v43, v42
    v_mul_f32 v20, v76, v20
    v_mul_f32 v21, v77, v21
    v_mul_f32 v22, v78, v22
    v_mul_f32 v23, v79, v23
    v_exp_f32 v20, v20
    v_exp_f32 v21, v21
    v_exp_f32 v22, v22
    v_exp_f32 v23, v23
    v_fma_f32 v20, v20, v41, v41
    v_fma_f32 v21, v21, v41, v41
    v_fma_f32 v22, v22, v41, v41
    v_fma_f32 v23, v23, v41, v41
    v_rcp_f32 v20, v20
    v_rcp_f32 v21, v21
    v_rcp_f32 v22, v22
    v_rcp_f32 v23, v23
    v_mul_f32 v20, v76, v20
    v_mul_f32 v21, v77, v21
    v_mul_f32 v22, v78, v22
    v_mul_f32 v23, v79, v23
    v_cvt_pk_bf16_f32 v54, v20, v21
    v_cvt_pk_bf16_f32 v55, v22, v23
    buffer_store_dwordx4 v[52:55], v13, s[28:31], s72 offen offset:1024 sc1
    s_add_u32 s72, s72, 2048
    s_cmp_eq_u32 s50, 7
    s_cbranch_scc0 X_DONE
    s_barrier
    ds_read2st64_b32 v[128:129], v57 offset0:0 offset1:1
    ds_read2st64_b32 v[130:131], v57 offset0:2 offset1:3
    ds_read2st64_b32 v[132:133], v57 offset0:4 offset1:5
    ds_read2st64_b32 v[134:135], v57 offset0:6 offset1:7
    ds_read2st64_b32 v[136:137], v57 offset0:8 offset1:9
    ds_read2st64_b32 v[138:139], v57 offset0:10 offset1:11
    ds_read2st64_b32 v[140:141], v57 offset0:12 offset1:13
    ds_read2st64_b32 v[142:143], v57 offset0:14 offset1:15
    s_waitcnt lgkmcnt(6)
    v_mul_f32 v16, v128, v128
    v_mul_f32 v17, v129, v129
    v_mul_f32 v18, v130, v130
    v_mul_f32 v19, v131, v131
    v_fma_f32 v16, v16, v43, v42
    v_fma_f32 v17, v17, v43, v42
    v_fma_f32 v18, v18, v43, v42
    v_fma_f32 v19, v19, v43, v42
    v_mul_f32 v16, v128, v16
    v_mul_f32 v17, v129, v17
    v_mul_f32 v18, v130, v18
    v_mul_f32 v19, v131, v19
    v_exp_f32 v16, v16
    v_exp_f32 v17, v17
    v_exp_f32 v18, v18
    v_exp_f32 v19, v19
    v_fma_f32 v16, v16, v41, v41
    v_fma_f32 v17, v17, v41, v41
    v_fma_f32 v18, v18, v41, v41
    v_fma_f32 v19, v19, v41, v41
    v_rcp_f32 v16, v16
    v_rcp_f32 v17, v17
    v_rcp_f32 v18, v18
    v_rcp_f32 v19, v19
    v_mul_f32 v16, v128, v16
    v_mul_f32 v17, v129, v17
    v_mul_f32 v18, v130, v18
    v_mul_f32 v19, v131, v19
    v_cvt_pk_bf16_f32 v48, v16, v17
    v_cvt_pk_bf16_f32 v49, v18, v19
    s_waitcnt lgkmcnt(4)
    v_mul_f32 v20, v132, v132
    v_mul_f32 v21, v133, v133
    v_mul_f32 v22, v134, v134
    v_mul_f32 v23, v135, v135
    v_fma_f32 v20, v20, v43, v42
    v_fma_f32 v21, v21, v43, v42
    v_fma_f32 v22, v22, v43, v42
    v_fma_f32 v23, v23, v43, v42
    v_mul_f32 v20, v132, v20
    v_mul_f32 v21, v133, v21
    v_mul_f32 v22, v134, v22
    v_mul_f32 v23, v135, v23
    v_exp_f32 v20, v20
    v_exp_f32 v21, v21
    v_exp_f32 v22, v22
    v_exp_f32 v23, v23
    v_fma_f32 v20, v20, v41, v41
    v_fma_f32 v21, v21, v41, v41
    v_fma_f32 v22, v22, v41, v41
    v_fma_f32 v23, v23, v41, v41
    v_rcp_f32 v20, v20
    v_rcp_f32 v21, v21
    v_rcp_f32 v22, v22
    v_rcp_f32 v23, v23
    v_mul_f32 v20, v132, v20
    v_mul_f32 v21, v133, v21
    v_mul_f32 v22, v134, v22
    v_mul_f32 v23, v135, v23
    v_cvt_pk_bf16_f32 v50, v20, v21
    v_cvt_pk_bf16_f32 v51, v22, v23
    s_waitcnt vmcnt(0)
    s_mov_b64 exec, 1
    buffer_store_dword v58, v59, s[28:31], s64 offen offset:0 sc1
    s_mov_b64 exec, -1
    buffer_store_dwordx4 v[48:51], v13, s[28:31], s72 offen offset:0 sc1
    s_waitcnt lgkmcnt(2)
    v_mul_f32 v16, v136, v136
    v_mul_f32 v17, v137, v137
    v_mul_f32 v18, v138, v138
    v_mul_f32 v19, v139, v139
    v_fma_f32 v16, v16, v43, v42
    v_fma_f32 v17, v17, v43, v42
    v_fma_f32 v18, v18, v43, v42
    v_fma_f32 v19, v19, v43, v42
    v_mul_f32 v16, v136, v16
    v_mul_f32 v17, v137, v17
    v_mul_f32 v18, v138, v18
    v_mul_f32 v19, v139, v19
    v_exp_f32 v16, v16
    v_exp_f32 v17, v17
    v_exp_f32 v18, v18
    v_exp_f32 v19, v19
    v_fma_f32 v16, v16, v41, v41
    v_fma_f32 v17, v17, v41, v41
    v_fma_f32 v18, v18, v41, v41
    v_fma_f32 v19, v19, v41, v41
    v_rcp_f32 v16, v16
    v_rcp_f32 v17, v17
    v_rcp_f32 v18, v18
    v_rcp_f32 v19, v19
    v_mul_f32 v16, v136, v16
    v_mul_f32 v17, v137, v17
    v_mul_f32 v18, v138, v18
    v_mul_f32 v19, v139, v19
    v_cvt_pk_bf16_f32 v52, v16, v17
    v_cvt_pk_bf16_f32 v53, v18, v19
    s_waitcnt lgkmcnt(0)
    v_mul_f32 v20, v140, v140
    v_mul_f32 v21, v141, v141
    v_mul_f32 v22, v142, v142
    v_mul_f32 v23, v143, v143
    v_fma_f32 v20, v20, v43, v42
    v_fma_f32 v21, v21, v43, v42
    v_fma_f32 v22, v22, v43, v42
    v_fma_f32 v23, v23, v43, v42
    v_mul_f32 v20, v140, v20
    v_mul_f32 v21, v141, v21
    v_mul_f32 v22, v142, v22
    v_mul_f32 v23, v143, v23
    v_exp_f32 v20, v20
    v_exp_f32 v21, v21
    v_exp_f32 v22, v22
    v_exp_f32 v23, v23
    v_fma_f32 v20, v20, v41, v41
    v_fma_f32 v21, v21, v41, v41
    v_fma_f32 v22, v22, v41, v41
    v_fma_f32 v23, v23, v41, v41
    v_rcp_f32 v20, v20
    v_rcp_f32 v21, v21
    v_rcp_f32 v22, v22
    v_rcp_f32 v23, v23
    v_mul_f32 v20, v140, v20
    v_mul_f32 v21, v141, v21
    v_mul_f32 v22, v142, v22
    v_mul_f32 v23, v143, v23
    v_cvt_pk_bf16_f32 v54, v20, v21
    v_cvt_pk_bf16_f32 v55, v22, v23
    buffer_store_dwordx4 v[52:55], v13, s[28:31], s72 offen offset:1024 sc1
    s_add_u32 s72, s72, 2048
    s_branch X_DONE
X_QK0:
    s_waitcnt lgkmcnt(6)
    v_mul_f32 v16, v40, v64
    v_mul_f32 v17, v40, v65
    v_mul_f32 v18, v40, v66
    v_mul_f32 v19, v40, v67
    v_cvt_pk_bf16_f32 v48, v16, v17
    v_cvt_pk_bf16_f32 v49, v18, v19
    buffer_store_dwordx2 v[48:49], v14, s[28:31], s72 offen offset:0 sc1
    s_waitcnt lgkmcnt(4)
    v_mul_f32 v20, v40, v68
    v_mul_f32 v21, v40, v69
    v_mul_f32 v22, v40, v70
    v_mul_f32 v23, v40, v71
    v_cvt_pk_bf16_f32 v50, v20, v21
    v_cvt_pk_bf16_f32 v51, v22, v23
    buffer_store_dwordx2 v[50:51], v14, s[28:31], s72 offen offset:512 sc1
    s_waitcnt lgkmcnt(2)
    v_mul_f32 v24, v40, v72
    v_mul_f32 v25, v40, v73
    v_mul_f32 v26, v40, v74
    v_mul_f32 v27, v40, v75
    v_cvt_pk_bf16_f32 v52, v24, v25
    v_cvt_pk_bf16_f32 v53, v26, v27
    buffer_store_dwordx2 v[52:53], v14, s[28:31], s72 offen offset:1024 sc1
    s_waitcnt lgkmcnt(0)
    v_mul_f32 v28, v40, v76
    v_mul_f32 v29, v40, v77
    v_mul_f32 v30, v40, v78
    v_mul_f32 v31, v40, v79
    v_cvt_pk_bf16_f32 v54, v28, v29
    v_cvt_pk_bf16_f32 v55, v30, v31
    buffer_store_dwordx2 v[54:55], v14, s[28:31], s72 offen offset:1536 sc1
    s_add_u32 s72, s72, 2048
    s_setpc_b64 s[90:91]
X_V0:
    ds_read_b128 v[16:19], v7 offset:0
    ds_read_b128 v[20:23], v7 offset:32
    ds_read_b128 v[24:27], v7 offset:64
    ds_read_b128 v[28:31], v7 offset:96
    s_sub_u32 s27, s72, s78
    s_lshr_b32 s27, s27, 4
    v_add_u32 v60, s27, v2
    v_mul_u32_u24 v60, 2341, v60
    v_lshrrev_b32 v60, 16, v60
    v_mad_u32_u24 v60, v60, s79, v15
    s_waitcnt lgkmcnt(2)
    v_mul_f32 v16, v16, v64
    v_mul_f32 v17, v17, v65
    v_mul_f32 v18, v18, v66
    v_mul_f32 v19, v19, v67
    v_mul_f32 v20, v20, v68
    v_mul_f32 v21, v21, v69
    v_mul_f32 v22, v22, v70
    v_mul_f32 v23, v23, v71
    v_cvt_pk_bf16_f32 v48, v16, v17
    v_cvt_pk_bf16_f32 v49, v18, v19
    v_cvt_pk_bf16_f32 v50, v20, v21
    v_cvt_pk_bf16_f32 v51, v22, v23
    buffer_store_dwordx4 v[48:51], v60, s[28:31], s72 offen offset:0 sc1
    s_waitcnt lgkmcnt(0)
    v_mul_f32 v24, v24, v72
    v_mul_f32 v25, v25, v73
    v_mul_f32 v26, v26, v74
    v_mul_f32 v27, v27, v75
    v_mul_f32 v28, v28, v76
    v_mul_f32 v29, v29, v77
    v_mul_f32 v30, v30, v78
    v_mul_f32 v31, v31, v79
    v_cvt_pk_bf16_f32 v52, v24, v25
    v_cvt_pk_bf16_f32 v53, v26, v27
    v_cvt_pk_bf16_f32 v54, v28, v29
    v_cvt_pk_bf16_f32 v55, v30, v31
    buffer_store_dwordx4 v[52:55], v60, s[28:31], s72 offen offset:896 sc1
    s_add_u32 s72, s72, 512
    s_setpc_b64 s[90:91]
X_QK1:
    s_waitcnt lgkmcnt(6)
    v_mul_f32 v16, v40, v128
    v_mul_f32 v17, v40, v129
    v_mul_f32 v18, v40, v130
    v_mul_f32 v19, v40, v131
    v_cvt_pk_bf16_f32 v48, v16, v17
    v_cvt_pk_bf16_f32 v49, v18, v19
    buffer_store_dwordx2 v[48:49], v14, s[28:31], s72 offen offset:0 sc1
    s_waitcnt lgkmcnt(4)
    v_mul_f32 v20, v40, v132
    v_mul_f32 v21, v40, v133
    v_mul_f32 v22, v40, v134
    v_mul_f32 v23, v40, v135
    v_cvt_pk_bf16_f32 v50, v20, v21
    v_cvt_pk_bf16_f32 v51, v22, v23
    buffer_store_dwordx2 v[50:51], v14, s[28:31], s72 offen offset:512 sc1
    s_waitcnt lgkmcnt(2)
    v_mul_f32 v24, v40, v136
    v_mul_f32 v25, v40, v137
    v_mul_f32 v26, v40, v138
    v_mul_f32 v27, v40, v139
    v_cvt_pk_bf16_f32 v52, v24, v25
    v_cvt_pk_bf16_f32 v53, v26, v27
    buffer_store_dwordx2 v[52:53], v14, s[28:31], s72 offen offset:1024 sc1
    s_waitcnt lgkmcnt(0)
    v_mul_f32 v28, v40, v140
    v_mul_f32 v29, v40, v141
    v_mul_f32 v30, v40, v142
    v_mul_f32 v31, v40, v143
    v_cvt_pk_bf16_f32 v54, v28, v29
    v_cvt_pk_bf16_f32 v55, v30, v31
    buffer_store_dwordx2 v[54:55], v14, s[28:31], s72 offen offset:1536 sc1
    s_add_u32 s72, s72, 2048
    s_setpc_b64 s[90:91]
X_V1:
    ds_read_b128 v[16:19], v7 offset:0
    ds_read_b128 v[20:23], v7 offset:32
    ds_read_b128 v[24:27], v7 offset:64
    ds_read_b128 v[28:31], v7 offset:96
    s_sub_u32 s27, s72, s78
    s_lshr_b32 s27, s27, 4
    v_add_u32 v60, s27, v2
    v_mul_u32_u24 v60, 2341, v60
    v_lshrrev_b32 v60, 16, v60
    v_mad_u32_u24 v60, v60, s79, v15
    s_waitcnt lgkmcnt(2)
    v_mul_f32 v16, v16, v128
    v_mul_f32 v17, v17, v129
    v_mul_f32 v18, v18, v130
    v_mul_f32 v19, v19, v131
    v_mul_f32 v20, v20, v132
    v_mul_f32 v21, v21, v133
    v_mul_f32 v22, v22, v134
    v_mul_f32 v23, v23, v135
    v_cvt_pk_bf16_f32 v48, v16, v17
    v_cvt_pk_bf16_f32 v49, v18, v19
    v_cvt_pk_bf16_f32 v50, v20, v21
    v_cvt_pk_bf16_f32 v51, v22, v23
    buffer_store_dwordx4 v[48:51], v60, s[28:31], s72 offen offset:0 sc1
    s_waitcnt lgkmcnt(0)
    v_mul_f32 v24, v24, v136
    v_mul_f32 v25, v25, v137
    v_mul_f32 v26, v26, v138
    v_mul_f32 v27, v27, v139
    v_mul_f32 v28, v28, v140
    v_mul_f32 v29, v29, v141
    v_mul_f32 v30, v30, v142
    v_mul_f32 v31, v31, v143
    v_cvt_pk_bf16_f32 v52, v24, v25
    v_cvt_pk_bf16_f32 v53, v26, v27
    v_cvt_pk_bf16_f32 v54, v28, v29
    v_cvt_pk_bf16_f32 v55, v30, v31
    buffer_store_dwordx4 v[52:55], v60, s[28:31], s72 offen offset:896 sc1
    s_add_u32 s72, s72, 512
    s_setpc_b64 s[90:91]
X_DONE:
    s_cmp_lt_u32 s53, 28
    s_cbranch_scc1 G_GO
    s_waitcnt vmcnt(0)
    s_mov_b64 exec, 1
    buffer_store_dword v58, v59, s[28:31], s64 offen offset:128 sc1
    s_mov_b64 exec, -1
    s_endpgm
G_GO:
    v_add_u32 v43, s65, v13
    v_mov_b32 v42, 161544
    v_subrev_u32 v40, 81920, v34
    v_subrev_u32 v41, 81920, v35
    v_lshlrev_b32 v64, 16, v80
    v_and_b32 v65, 0xffff0000, v80
    v_lshlrev_b32 v16, 16, v88
    v_and_b32 v17, 0xffff0000, v88
    v_lshlrev_b32 v66, 16, v81
    v_and_b32 v67, 0xffff0000, v81
    v_lshlrev_b32 v18, 16, v89
    v_and_b32 v19, 0xffff0000, v89
    v_lshlrev_b32 v68, 16, v82
    v_and_b32 v69, 0xffff0000, v82
    v_lshlrev_b32 v20, 16, v90
    v_and_b32 v21, 0xffff0000, v90
    v_lshlrev_b32 v70, 16, v83
    v_and_b32 v71, 0xffff0000, v83
    v_lshlrev_b32 v22, 16, v91
    v_and_b32 v23, 0xffff0000, v91
    v_lshlrev_b32 v72, 16, v84
    v_and_b32 v73, 0xffff0000, v84
    v_lshlrev_b32 v24, 16, v92
    v_and_b32 v25, 0xffff0000, v92
    v_lshlrev_b32 v74, 16, v85
    v_and_b32 v75, 0xffff0000, v85
    v_lshlrev_b32 v26, 16, v93
    v_and_b32 v27, 0xffff0000, v93
    v_lshlrev_b32 v76, 16, v86
    v_and_b32 v77, 0xffff0000, v86
    v_lshlrev_b32 v28, 16, v94
    v_and_b32 v29, 0xffff0000, v94
    v_lshlrev_b32 v78, 16, v87
    v_and_b32 v79, 0xffff0000, v87
    v_lshlrev_b32 v30, 16, v95
    v_and_b32 v31, 0xffff0000, v95
    v_add_f32 v80, v64, v16
    v_add_f32 v81, v65, v17
    v_add_f32 v82, v66, v18
    v_add_f32 v83, v67, v19
    v_add_f32 v84, v68, v20
    v_add_f32 v85, v69, v21
    v_add_f32 v86, v70, v22
    v_add_f32 v87, v71, v23
    v_add_f32 v88, v72, v24
    v_add_f32 v89, v73, v25
    v_add_f32 v90, v74, v26
    v_add_f32 v91, v75, v27
    v_add_f32 v92, v76, v28
    v_add_f32 v93, v77, v29
    v_add_f32 v94, v78, v30
    v_add_f32 v95, v79, v31
    ds_write_b128 v43, v[96:99] offset:0
    ds_write_b128 v43, v[100:103] offset:1024
    ds_write_b128 v43, v[104:107] offset:2048
    ds_write_b128 v43, v[108:111] offset:3072
    ds_write_b128 v43, v[112:115] offset:4096
    ds_write_b128 v43, v[116:119] offset:5120
    ds_write_b128 v43, v[120:123] offset:6144
    ds_write_b128 v43, v[124:127] offset:7168
    s_waitcnt vmcnt(0)
    s_mov_b64 exec, 1
    buffer_store_dword v58, v59, s[28:31], s64 offen offset:0 sc1
    s_mov_b64 exec, -1
    s_setprio 0
    v_cmp_ne_u32 s[88:89], s47, v62
    s_nop 0
    s_and_b32 s88, s88, 15
    s_cbranch_scc0 G_OK0
    s_mov_b32 s27, 65536
    s_mov_b32 exec_lo, s88
    s_mov_b32 exec_hi, 0
    s_branch G_P0_L
G_P0:
    s_mov_b64 exec, s[88:89]
    s_sleep 3
G_P0_L:
    buffer_load_dword v61, v36, s[28:31], 0 offen sc1
    s_waitcnt vmcnt(0)
    v_cmp_ne_u32 s[88:89], s47, v61
    s_sub_u32 s27, s27, 1
    s_cbranch_scc1 G_P0_X
    s_cmp_lg_u64 s[88:89], 0
    s_cbranch_scc1 G_P0
G_P0_X:
    s_mov_b64 exec, -1
G_OK0:
    s_add_u32 s70, s44, 0
    s_add_u32 s71, s45, 0
    buffer_load_dwordx4 v[16:19], v13, s[28:31], s70 offen offset:0 sc1
    buffer_load_dwordx4 v[20:23], v13, s[28:31], s71 offen offset:0 sc1
    buffer_load_dwordx4 v[24:27], v13, s[28:31], s70 offen offset:1024 sc1
    buffer_load_dwordx4 v[28:31], v13, s[28:31], s71 offen offset:1024 sc1
    s_add_u32 s70, s44, 16384
    s_add_u32 s71, s45, 16384
    buffer_load_dwordx4 v[128:131], v13, s[28:31], s70 offen offset:0 sc1
    buffer_load_dwordx4 v[132:135], v13, s[28:31], s71 offen offset:0 sc1
    buffer_load_dwordx4 v[136:139], v13, s[28:31], s70 offen offset:1024 sc1
    buffer_load_dwordx4 v[140:143], v13, s[28:31], s71 offen offset:1024 sc1
    s_mov_b32 s27, 4194304
    s_branch G_LW_L
G_LW:
    s_sleep 1
G_LW_L:
    ds_read_b32 v56, v42
    s_waitcnt lgkmcnt(0)
    v_readfirstlane_b32 s88, v56
    s_sub_u32 s27, s27, 1
    s_cbranch_scc1 G_LW_X
    s_cmp_lt_u32 s88, 4
    s_cbranch_scc1 G_LW
G_LW_X:
    s_add_u32 m0, s14, 36864
    s_add_u32 s27, s12, 28672
    buffer_load_dwordx4 v32, s[16:19], s27 offen lds
    buffer_load_dwordx4 v33, s[16:19], s27 offen offset:1024 lds
    s_add_u32 m0, s14, 38912
    s_add_u32 s27, s12, 43008
    buffer_load_dwordx4 v32, s[16:19], s27 offen lds
    buffer_load_dwordx4 v33, s[16:19], s27 offen offset:1024 lds
    s_add_u32 m0, s14, 40960
    s_add_u32 s27, s12, 258048
    buffer_load_dwordx4 v32, s[16:19], s27 offen lds
    buffer_load_dwordx4 v33, s[16:19], s27 offen offset:1024 lds
    s_add_u32 m0, s14, 43008
    s_add_u32 s27, s12, 272384
    buffer_load_dwordx4 v32, s[16:19], s27 offen lds
    buffer_load_dwordx4 v33, s[16:19], s27 offen offset:1024 lds
    ds_read_b64_tr_b16 v[4:5], v40 offset:0
    ds_read_b64_tr_b16 v[6:7], v40 offset:256
    ds_read_b64_tr_b16 v[8:9], v41 offset:0
    ds_read_b64_tr_b16 v[10:11], v41 offset:256
    s_waitcnt vmcnt(14)
    s_waitcnt lgkmcnt(0)
    v_mfma_f32_32x32x16_bf16 v[80:95], v[4:7], v[16:19], v[80:95]
    ds_read_b64_tr_b16 v[48:49], v40 offset:2048
    ds_read_b64_tr_b16 v[50:51], v40 offset:2304
    ds_read_b64_tr_b16 v[52:53], v41 offset:2048
    ds_read_b64_tr_b16 v[54:55], v41 offset:2304
    v_mfma_f32_32x32x16_bf16 v[64:79], v[4:7], v[20:23], 0
    ds_write_b128 v43, v[192:195] offset:0
    ds_write_b128 v43, v[196:199] offset:1024
    v_mfma_f32_32x32x16_bf16 v[96:111], v[8:11], v[16:19], 0
    s_add_u32 m0, s14, 0
    s_add_u32 s27, s12, 458752
    buffer_load_dwordx4 v32, s[16:19], s27 offen lds
    buffer_load_dwordx4 v33, s[16:19], s27 offen offset:1024 lds
    v_mfma_f32_32x32x16_bf16 v[112:127], v[8:11], v[20:23], 0
    s_add_u32 m0, s14, 2048
    s_add_u32 s27, s12, 473088
    buffer_load_dwordx4 v32, s[16:19], s27 offen lds
    buffer_load_dwordx4 v33, s[16:19], s27 offen offset:1024 lds
    s_waitcnt vmcnt(16)
    s_waitcnt lgkmcnt(0)
    v_mfma_f32_32x32x16_bf16 v[80:95], v[48:51], v[24:27], v[80:95]
    ds_read_b64_tr_b16 v[4:5], v40 offset:4096
    ds_read_b64_tr_b16 v[6:7], v40 offset:4352
    ds_read_b64_tr_b16 v[8:9], v41 offset:4096
    ds_read_b64_tr_b16 v[10:11], v41 offset:4352
    v_mfma_f32_32x32x16_bf16 v[64:79], v[48:51], v[28:31], v[64:79]
    ds_write_b128 v43, v[200:203] offset:2048
    ds_write_b128 v43, v[204:207] offset:3072
    v_mfma_f32_32x32x16_bf16 v[96:111], v[52:55], v[24:27], v[96:111]
    s_add_u32 m0, s14, 4096
    s_add_u32 s27, s12, 487424
    buffer_load_dwordx4 v32, s[16:19], s27 offen lds
    buffer_load_dwordx4 v33, s[16:19], s27 offen offset:1024 lds
    v_mfma_f32_32x32x16_bf16 v[112:127], v[52:55], v[28:31], v[112:127]
    s_add_u32 m0, s14, 6144
    s_add_u32 s27, s12, 501760
    buffer_load_dwordx4 v32, s[16:19], s27 offen lds
    buffer_load_dwordx4 v33, s[16:19], s27 offen offset:1024 lds
    s_waitcnt vmcnt(18)
    s_waitcnt lgkmcnt(0)
    v_mfma_f32_32x32x16_bf16 v[80:95], v[4:7], v[128:131], v[80:95]
    ds_read_b64_tr_b16 v[48:49], v40 offset:6144
    ds_read_b64_tr_b16 v[50:51], v40 offset:6400
    ds_read_b64_tr_b16 v[52:53], v41 offset:6144
    ds_read_b64_tr_b16 v[54:55], v41 offset:6400
    v_mfma_f32_32x32x16_bf16 v[64:79], v[4:7], v[132:135], v[64:79]
    ds_write_b128 v43, v[208:211] offset:4096
    ds_write_b128 v43, v[212:215] offset:5120
    s_mov_b64 exec, 16777200
    buffer_load_dword v60, v36, s[28:31], 0 offen sc1
    s_mov_b64 exec, -1
    v_mfma_f32_32x32x16_bf16 v[96:111], v[8:11], v[128:131], v[96:111]
    s_add_u32 s27, s12, 946176
    buffer_load_dwordx4 v[192:195], v32, s[16:19], s27 offen
    buffer_load_dwordx4 v[196:199], v33, s[16:19], s27 offen offset:1024
    s_add_u32 s27, s12, 960512
    buffer_load_dwordx4 v[200:203], v32, s[16:19], s27 offen
    v_mfma_f32_32x32x16_bf16 v[112:127], v[8:11], v[132:135], v[112:127]
    buffer_load_dwordx4 v[204:207], v33, s[16:19], s27 offen offset:1024
    s_waitcnt vmcnt(19)
    s_waitcnt lgkmcnt(0)
    v_mfma_f32_32x32x16_bf16 v[80:95], v[48:51], v[136:139], v[80:95]
    ds_read_b64_tr_b16 v[4:5], v34 offset:36864
    ds_read_b64_tr_b16 v[6:7], v34 offset:37120
    ds_read_b64_tr_b16 v[8:9], v35 offset:36864
    ds_read_b64_tr_b16 v[10:11], v35 offset:37120
    v_mfma_f32_32x32x16_bf16 v[64:79], v[48:51], v[140:143], v[64:79]
    ds_write_b128 v43, v[216:219] offset:6144
    ds_write_b128 v43, v[220:223] offset:7168
    v_mfma_f32_32x32x16_bf16 v[96:111], v[52:55], v[136:139], v[96:111]
    s_add_u32 s27, s12, 1175552
    buffer_load_dwordx4 v[208:211], v32, s[16:19], s27 offen
    buffer_load_dwordx4 v[212:215], v33, s[16:19], s27 offen offset:1024
    v_mfma_f32_32x32x16_bf16 v[112:127], v[52:55], v[140:143], v[112:127]
    s_waitcnt vmcnt(6)
    v_cmp_ne_u32 s[88:89], s47, v60
    s_nop 0
    s_and_b32 s88, s88, 16777200
    s_cbranch_scc0 G_HK4
    s_mov_b32 s27, 65536
    s_mov_b32 exec_lo, s88
    s_mov_b32 exec_hi, 0
    s_branch G_HP4_L
G_HP4:
    s_mov_b64 exec, s[88:89]
    s_sleep 3
G_HP4_L:
    buffer_load_dword v60, v36, s[28:31], 0 offen sc1
    s_waitcnt vmcnt(0)
    v_cmp_ne_u32 s[88:89], s47, v60
    s_sub_u32 s27, s27, 1
    s_cbranch_scc1 G_HP4_X
    s_cmp_lg_u64 s[88:89], 0
    s_cbranch_scc1 G_HP4
G_HP4_X:
    s_mov_b64 exec, -1
G_HK4:
    s_add_u32 s70, s44, 2048
    s_add_u32 s71, s45, 2048
    buffer_load_dwordx4 v[144:147], v13, s[28:31], s70 offen offset:0 sc1
    buffer_load_dwordx4 v[148:151], v13, s[28:31], s71 offen offset:0 sc1
    buffer_load_dwordx4 v[152:155], v13, s[28:31], s70 offen offset:1024 sc1
    buffer_load_dwordx4 v[156:159], v13, s[28:31], s71 offen offset:1024 sc1
    s_add_u32 s70, s44, 18432
    s_add_u32 s71, s45, 18432
    buffer_load_dwordx4 v[160:163], v13, s[28:31], s70 offen offset:0 sc1
    buffer_load_dwordx4 v[164:167], v13, s[28:31], s71 offen offset:0 sc1
    buffer_load_dwordx4 v[168:171], v13, s[28:31], s70 offen offset:1024 sc1
    buffer_load_dwordx4 v[172:175], v13, s[28:31], s71 offen offset:1024 sc1
    s_add_u32 s70, s44, 32768
    s_add_u32 s71, s45, 32768
    buffer_load_dwordx4 v[176:179], v13, s[28:31], s70 offen offset:0 sc1
    buffer_load_dwordx4 v[180:183], v13, s[28:31], s71 offen offset:0 sc1
    buffer_load_dwordx4 v[184:187], v13, s[28:31], s70 offen offset:1024 sc1
    buffer_load_dwordx4 v[188:191], v13, s[28:31], s71 offen offset:1024 sc1
    s_add_u32 s70, s44, 34816
    s_add_u32 s71, s45, 34816
    buffer_load_dwordx4 v[16:19], v13, s[28:31], s70 offen offset:0 sc1
    buffer_load_dwordx4 v[20:23], v13, s[28:31], s71 offen offset:0 sc1
    buffer_load_dwordx4 v[24:27], v13, s[28:31], s70 offen offset:1024 sc1
    buffer_load_dwordx4 v[28:31], v13, s[28:31], s71 offen offset:1024 sc1
    s_add_u32 s70, s44, 49152
    s_add_u32 s71, s45, 49152
    buffer_load_dwordx4 v[128:131], v13, s[28:31], s70 offen offset:0 sc1
    buffer_load_dwordx4 v[132:135], v13, s[28:31], s71 offen offset:0 sc1
    buffer_load_dwordx4 v[136:139], v13, s[28:31], s70 offen offset:1024 sc1
    buffer_load_dwordx4 v[140:143], v13, s[28:31], s71 offen offset:1024 sc1
    s_waitcnt vmcnt(18)
    s_waitcnt lgkmcnt(0)
    v_mfma_f32_32x32x16_bf16 v[80:95], v[4:7], v[144:147], v[80:95]
    ds_read_b64_tr_b16 v[48:49], v34 offset:38912
    ds_read_b64_tr_b16 v[50:51], v34 offset:39168
    ds_read_b64_tr_b16 v[52:53], v35 offset:38912
    ds_read_b64_tr_b16 v[54:55], v35 offset:39168
    v_mfma_f32_32x32x16_bf16 v[64:79], v[4:7], v[148:151], v[64:79]
    ds_write_b128 v38, v[224:227] offset:36864
    ds_write_b128 v38, v[228:231] offset:37888
    v_mfma_f32_32x32x16_bf16 v[96:111], v[8:11], v[144:147], v[96:111]
    s_add_u32 s27, s12, 1189888
    buffer_load_dwordx4 v[216:219], v32, s[16:19], s27 offen
    buffer_load_dwordx4 v[220:223], v33, s[16:19], s27 offen offset:1024
    v_mfma_f32_32x32x16_bf16 v[112:127], v[8:11], v[148:151], v[112:127]
    s_waitcnt vmcnt(18)
    s_waitcnt lgkmcnt(0)
    v_mfma_f32_32x32x16_bf16 v[80:95], v[48:51], v[152:155], v[80:95]
    ds_read_b64_tr_b16 v[4:5], v34 offset:40960
    ds_read_b64_tr_b16 v[6:7], v34 offset:41216
    ds_read_b64_tr_b16 v[8:9], v35 offset:40960
    ds_read_b64_tr_b16 v[10:11], v35 offset:41216
    v_mfma_f32_32x32x16_bf16 v[64:79], v[48:51], v[156:159], v[64:79]
    ds_write_b128 v38, v[232:235] offset:38912
    ds_write_b128 v38, v[236:239] offset:39936
    v_mfma_f32_32x32x16_bf16 v[96:111], v[52:55], v[152:155], v[96:111]
    s_add_u32 s70, s44, 65536
    s_add_u32 s71, s45, 65536
    buffer_load_dwordx4 v[144:147], v13, s[28:31], s70 offen offset:0 sc1
    buffer_load_dwordx4 v[148:151], v13, s[28:31], s71 offen offset:0 sc1
    v_mfma_f32_32x32x16_bf16 v[112:127], v[52:55], v[156:159], v[112:127]
    s_add_u32 s27, s12, 1376256
    buffer_load_dwordx4 v[224:227], v32, s[16:19], s27 offen
    buffer_load_dwordx4 v[228:231], v33, s[16:19], s27 offen offset:1024
    s_waitcnt vmcnt(20)
    s_waitcnt lgkmcnt(0)
    v_mfma_f32_32x32x16_bf16 v[80:95], v[4:7], v[160:163], v[80:95]
    ds_read_b64_tr_b16 v[48:49], v34 offset:43008
    ds_read_b64_tr_b16 v[50:51], v34 offset:43264
    ds_read_b64_tr_b16 v[52:53], v35 offset:43008
    ds_read_b64_tr_b16 v[54:55], v35 offset:43264
    v_mfma_f32_32x32x16_bf16 v[64:79], v[4:7], v[164:167], v[64:79]
    ds_write_b128 v38, v[240:243] offset:40960
    ds_write_b128 v38, v[244:247] offset:41984
    v_mfma_f32_32x32x16_bf16 v[96:111], v[8:11], v[160:163], v[96:111]
    buffer_load_dwordx4 v[152:155], v13, s[28:31], s70 offen offset:1024 sc1
    buffer_load_dwordx4 v[156:159], v13, s[28:31], s71 offen offset:1024 sc1
    v_mfma_f32_32x32x16_bf16 v[112:127], v[8:11], v[164:167], v[112:127]
    s_add_u32 s27, s12, 1390592
    buffer_load_dwordx4 v[232:235], v32, s[16:19], s27 offen
    buffer_load_dwordx4 v[236:239], v33, s[16:19], s27 offen offset:1024
    s_waitcnt vmcnt(22)
    s_waitcnt lgkmcnt(0)
    v_mfma_f32_32x32x16_bf16 v[80:95], v[48:51], v[168:171], v[80:95]
    ds_read_b64_tr_b16 v[4:5], v34 offset:0
    ds_read_b64_tr_b16 v[6:7], v34 offset:256
    ds_read_b64_tr_b16 v[8:9], v35 offset:0
    ds_read_b64_tr_b16 v[10:11], v35 offset:256
    v_mfma_f32_32x32x16_bf16 v[64:79], v[48:51], v[172:175], v[64:79]
    ds_write_b128 v38, v[248:251] offset:43008
    ds_write_b128 v38, v[252:255] offset:44032
    v_mfma_f32_32x32x16_bf16 v[96:111], v[52:55], v[168:171], v[96:111]
    s_add_u32 s70, s44, 81920
    s_add_u32 s71, s45, 81920
    buffer_load_dwordx4 v[160:163], v13, s[28:31], s70 offen offset:0 sc1
    buffer_load_dwordx4 v[164:167], v13, s[28:31], s71 offen offset:0 sc1
    v_mfma_f32_32x32x16_bf16 v[112:127], v[52:55], v[172:175], v[112:127]
    s_add_u32 s27, s12, 1404928
    buffer_load_dwordx4 v[240:243], v32, s[16:19], s27 offen
    buffer_load_dwordx4 v[244:247], v33, s[16:19], s27 offen offset:1024
    s_waitcnt vmcnt(24)
    s_waitcnt lgkmcnt(0)
    v_mfma_f32_32x32x16_bf16 v[80:95], v[4:7], v[176:179], v[80:95]
    ds_read_b64_tr_b16 v[48:49], v34 offset:2048
    ds_read_b64_tr_b16 v[50:51], v34 offset:2304
    ds_read_b64_tr_b16 v[52:53], v35 offset:2048
    ds_read_b64_tr_b16 v[54:55], v35 offset:2304
    v_mfma_f32_32x32x16_bf16 v[64:79], v[4:7], v[180:183], v[64:79]
    ds_write_b128 v38, v[192:195] offset:0
    ds_write_b128 v38, v[196:199] offset:1024
    v_mfma_f32_32x32x16_bf16 v[96:111], v[8:11], v[176:179], v[96:111]
    buffer_load_dwordx4 v[168:171], v13, s[28:31], s70 offen offset:1024 sc1
    buffer_load_dwordx4 v[172:175], v13, s[28:31], s71 offen offset:1024 sc1
    v_mfma_f32_32x32x16_bf16 v[112:127], v[8:11], v[180:183], v[112:127]
    s_add_u32 s27, s12, 1419264
    buffer_load_dwordx4 v[248:251], v32, s[16:19], s27 offen
    buffer_load_dwordx4 v[252:255], v33, s[16:19], s27 offen offset:1024
    s_waitcnt vmcnt(26)
    s_waitcnt lgkmcnt(0)
    v_mfma_f32_32x32x16_bf16 v[80:95], v[48:51], v[184:187], v[80:95]
    ds_read_b64_tr_b16 v[4:5], v34 offset:4096
    ds_read_b64_tr_b16 v[6:7], v34 offset:4352
    ds_read_b64_tr_b16 v[8:9], v35 offset:4096
    ds_read_b64_tr_b16 v[10:11], v35 offset:4352
    v_mfma_f32_32x32x16_bf16 v[64:79], v[48:51], v[188:191], v[64:79]
    ds_write_b128 v38, v[200:203] offset:2048
    ds_write_b128 v38, v[204:207] offset:3072
    v_mfma_f32_32x32x16_bf16 v[96:111], v[52:55], v[184:187], v[96:111]
    s_add_u32 s70, s44, 51200
    s_add_u32 s71, s45, 51200
    buffer_load_dwordx4 v[176:179], v13, s[28:31], s70 offen offset:0 sc1
    buffer_load_dwordx4 v[180:183], v13, s[28:31], s71 offen offset:0 sc1
    v_mfma_f32_32x32x16_bf16 v[112:127], v[52:55], v[188:191], v[112:127]
    s_waitcnt vmcnt(26)
    s_waitcnt lgkmcnt(0)
    v_mfma_f32_32x32x16_bf16 v[80:95], v[4:7], v[16:19], v[80:95]
    ds_read_b64_tr_b16 v[48:49], v34 offset:6144
    ds_read_b64_tr_b16 v[50:51], v34 offset:6400
    ds_read_b64_tr_b16 v[52:53], v35 offset:6144
    ds_read_b64_tr_b16 v[54:55], v35 offset:6400
    v_mfma_f32_32x32x16_bf16 v[64:79], v[4:7], v[20:23], v[64:79]
    ds_write_b128 v38, v[208:211] offset:4096
    ds_write_b128 v38, v[212:215] offset:5120
    v_mfma_f32_32x32x16_bf16 v[96:111], v[8:11], v[16:19], v[96:111]
    s_mov_b64 exec, 251658240
    buffer_load_dword v60, v36, s[28:31], 0 offen sc1
    s_mov_b64 exec, -1
    buffer_load_dwordx4 v[184:187], v13, s[28:31], s70 offen offset:1024 sc1
    v_mfma_f32_32x32x16_bf16 v[112:127], v[8:11], v[20:23], v[112:127]
    buffer_load_dwordx4 v[188:191], v13, s[28:31], s71 offen offset:1024 sc1
    s_waitcnt vmcnt(21)
    s_waitcnt lgkmcnt(0)
    v_mfma_f32_32x32x16_bf16 v[80:95], v[48:51], v[24:27], v[80:95]
    ds_read_b64_tr_b16 v[4:5], v40 offset:0
    ds_read_b64_tr_b16 v[6:7], v40 offset:256
    ds_read_b64_tr_b16 v[8:9], v41 offset:0
    ds_read_b64_tr_b16 v[10:11], v41 offset:256
    v_mfma_f32_32x32x16_bf16 v[64:79], v[48:51], v[28:31], v[64:79]
    ds_write_b128 v38, v[216:219] offset:6144
    ds_write_b128 v38, v[220:223] offset:7168
    v_mfma_f32_32x32x16_bf16 v[96:111], v[52:55], v[24:27], v[96:111]
    s_add_u32 s70, s44, 67584
    s_add_u32 s71, s45, 67584
    buffer_load_dwordx4 v[16:19], v13, s[28:31], s70 offen offset:0 sc1
    buffer_load_dwordx4 v[20:23], v13, s[28:31], s71 offen offset:0 sc1
    v_mfma_f32_32x32x16_bf16 v[112:127], v[52:55], v[28:31], v[112:127]
    s_waitcnt vmcnt(19)
    s_waitcnt lgkmcnt(0)
    v_mfma_f32_32x32x16_bf16 v[80:95], v[4:7], v[128:131], v[80:95]
    ds_read_b64_tr_b16 v[48:49], v40 offset:2048
    ds_read_b64_tr_b16 v[50:51], v40 offset:2304
    ds_read_b64_tr_b16 v[52:53], v41 offset:2048
    ds_read_b64_tr_b16 v[54:55], v41 offset:2304
    v_mfma_f32_32x32x16_bf16 v[64:79], v[4:7], v[132:135], v[64:79]
    ds_write_b128 v43, v[224:227] offset:0
    ds_write_b128 v43, v[228:231] offset:1024
    v_mfma_f32_32x32x16_bf16 v[96:111], v[8:11], v[128:131], v[96:111]
    buffer_load_dwordx4 v[24:27], v13, s[28:31], s70 offen offset:1024 sc1
    buffer_load_dwordx4 v[28:31], v13, s[28:31], s71 offen offset:1024 sc1
    v_mfma_f32_32x32x16_bf16 v[112:127], v[8:11], v[132:135], v[112:127]
    s_waitcnt vmcnt(17)
    s_waitcnt lgkmcnt(0)
    v_mfma_f32_32x32x16_bf16 v[80:95], v[48:51], v[136:139], v[80:95]
    ds_read_b64_tr_b16 v[4:5], v40 offset:4096
    ds_read_b64_tr_b16 v[6:7], v40 offset:4352
    ds_read_b64_tr_b16 v[8:9], v41 offset:4096
    ds_read_b64_tr_b16 v[10:11], v41 offset:4352
    v_mfma_f32_32x32x16_bf16 v[64:79], v[48:51], v[140:143], v[64:79]
    ds_write_b128 v43, v[232:235] offset:2048
    ds_write_b128 v43, v[236:239] offset:3072
    v_mfma_f32_32x32x16_bf16 v[96:111], v[52:55], v[136:139], v[96:111]
    s_add_u32 s70, s44, 83968
    s_add_u32 s71, s45, 83968
    buffer_load_dwordx4 v[128:131], v13, s[28:31], s70 offen offset:0 sc1
    buffer_load_dwordx4 v[132:135], v13, s[28:31], s71 offen offset:0 sc1
    v_mfma_f32_32x32x16_bf16 v[112:127], v[52:55], v[140:143], v[112:127]
    s_waitcnt vmcnt(15)
    s_waitcnt lgkmcnt(0)
    v_mfma_f32_32x32x16_bf16 v[80:95], v[4:7], v[144:147], v[80:95]
    ds_read_b64_tr_b16 v[48:49], v40 offset:6144
    ds_read_b64_tr_b16 v[50:51], v40 offset:6400
    ds_read_b64_tr_b16 v[52:53], v41 offset:6144
    ds_read_b64_tr_b16 v[54:55], v41 offset:6400
    v_mfma_f32_32x32x16_bf16 v[64:79], v[4:7], v[148:151], v[64:79]
    ds_write_b128 v43, v[240:243] offset:4096
    ds_write_b128 v43, v[244:247] offset:5120
    v_mfma_f32_32x32x16_bf16 v[96:111], v[8:11], v[144:147], v[96:111]
    buffer_load_dwordx4 v[136:139], v13, s[28:31], s70 offen offset:1024 sc1
    buffer_load_dwordx4 v[140:143], v13, s[28:31], s71 offen offset:1024 sc1
    v_mfma_f32_32x32x16_bf16 v[112:127], v[8:11], v[148:151], v[112:127]
    s_waitcnt vmcnt(13)
    s_waitcnt lgkmcnt(0)
    v_mfma_f32_32x32x16_bf16 v[80:95], v[48:51], v[152:155], v[80:95]
    ds_read_b64_tr_b16 v[4:5], v34 offset:36864
    ds_read_b64_tr_b16 v[6:7], v34 offset:37120
    ds_read_b64_tr_b16 v[8:9], v35 offset:36864
    ds_read_b64_tr_b16 v[10:11], v35 offset:37120
    v_mfma_f32_32x32x16_bf16 v[64:79], v[48:51], v[156:159], v[64:79]
    ds_write_b128 v43, v[248:251] offset:6144
    v_mfma_f32_32x32x16_bf16 v[96:111], v[52:55], v[152:155], v[96:111]
    ds_write_b128 v43, v[252:255] offset:7168
    v_mfma_f32_32x32x16_bf16 v[112:127], v[52:55], v[156:159], v[112:127]
    s_waitcnt vmcnt(10)
    v_cmp_ne_u32 s[88:89], s47, v60
    s_nop 0
    s_and_b32 s88, s88, 251658240
    s_cbranch_scc0 G_HK16
    s_mov_b32 s27, 65536
    s_mov_b32 exec_lo, s88
    s_mov_b32 exec_hi, 0
    s_branch G_HP16_L
G_HP16:
    s_mov_b64 exec, s[88:89]
    s_sleep 3
G_HP16_L:
    buffer_load_dword v60, v36, s[28:31], 0 offen sc1
    s_waitcnt vmcnt(0)
    v_cmp_ne_u32 s[88:89], s47, v60
    s_sub_u32 s27, s27, 1
    s_cbranch_scc1 G_HP16_X
    s_cmp_lg_u64 s[88:89], 0
    s_cbranch_scc1 G_HP16
G_HP16_X:
    s_mov_b64 exec, -1
G_HK16:
    s_add_u32 s70, s44, 98304
    s_add_u32 s71, s45, 98304
    buffer_load_dwordx4 v[144:147], v13, s[28:31], s70 offen offset:0 sc1
    buffer_load_dwordx4 v[148:151], v13, s[28:31], s71 offen offset:0 sc1
    buffer_load_dwordx4 v[152:155], v13, s[28:31], s70 offen offset:1024 sc1
    buffer_load_dwordx4 v[156:159], v13, s[28:31], s71 offen offset:1024 sc1
    s_waitcnt lgkmcnt(0)
    v_mfma_f32_32x32x16_bf16 v[80:95], v[4:7], v[160:163], v[80:95]
    ds_read_b64_tr_b16 v[48:49], v34 offset:38912
    ds_read_b64_tr_b16 v[50:51], v34 offset:39168
    ds_read_b64_tr_b16 v[52:53], v35 offset:38912
    ds_read_b64_tr_b16 v[54:55], v35 offset:39168
    v_mfma_f32_32x32x16_bf16 v[64:79], v[4:7], v[164:167], v[64:79]
    s_add_u32 m0, s14, 36864
    s_add_u32 s27, s13, 0
    buffer_load_dwordx4 v32, s[8:11], s27 offen lds
    v_mfma_f32_32x32x16_bf16 v[96:111], v[8:11], v[160:163], v[96:111]
    buffer_load_dwordx4 v33, s[8:11], s27 offen offset:1024 lds
    v_mfma_f32_32x32x16_bf16 v[112:127], v[8:11], v[164:167], v[112:127]
    s_waitcnt lgkmcnt(0)
    v_mfma_f32_32x32x16_bf16 v[80:95], v[48:51], v[168:171], v[80:95]
    ds_read_b64_tr_b16 v[4:5], v34 offset:40960
    ds_read_b64_tr_b16 v[6:7], v34 offset:41216
    ds_read_b64_tr_b16 v[8:9], v35 offset:40960
    ds_read_b64_tr_b16 v[10:11], v35 offset:41216
    v_mfma_f32_32x32x16_bf16 v[64:79], v[48:51], v[172:175], v[64:79]
    s_add_u32 s70, s44, 100352
    s_add_u32 s71, s45, 100352
    buffer_load_dwordx4 v[160:163], v13, s[28:31], s70 offen offset:0 sc1
    buffer_load_dwordx4 v[164:167], v13, s[28:31], s71 offen offset:0 sc1
    v_mfma_f32_32x32x16_bf16 v[96:111], v[52:55], v[168:171], v[96:111]
    s_add_u32 m0, s14, 38912
    s_add_u32 s27, s13, 14336
    buffer_load_dwordx4 v32, s[8:11], s27 offen lds
    buffer_load_dwordx4 v33, s[8:11], s27 offen offset:1024 lds
    v_mfma_f32_32x32x16_bf16 v[112:127], v[52:55], v[172:175], v[112:127]
    s_waitcnt lgkmcnt(0)
    v_mfma_f32_32x32x16_bf16 v[80:95], v[4:7], v[176:179], v[80:95]
    ds_read_b64_tr_b16 v[48:49], v34 offset:43008
    ds_read_b64_tr_b16 v[50:51], v34 offset:43264
    ds_read_b64_tr_b16 v[52:53], v35 offset:43008
    ds_read_b64_tr_b16 v[54:55], v35 offset:43264
    v_mfma_f32_32x32x16_bf16 v[64:79], v[4:7], v[180:183], v[64:79]
    buffer_load_dwordx4 v[168:171], v13, s[28:31], s70 offen offset:1024 sc1
    buffer_load_dwordx4 v[172:175], v13, s[28:31], s71 offen offset:1024 sc1
    v_mfma_f32_32x32x16_bf16 v[96:111], v[8:11], v[176:179], v[96:111]
    s_add_u32 m0, s14, 40960
    s_add_u32 s27, s13, 25088
    buffer_load_dwordx4 v32, s[8:11], s27 offen lds
    buffer_load_dwordx4 v33, s[8:11], s27 offen offset:1024 lds
    v_mfma_f32_32x32x16_bf16 v[112:127], v[8:11], v[180:183], v[112:127]
    s_waitcnt vmcnt(22)
    s_waitcnt lgkmcnt(0)
    v_mfma_f32_32x32x16_bf16 v[80:95], v[48:51], v[184:187], v[80:95]
    ds_read_b64_tr_b16 v[4:5], v34 offset:0
    ds_read_b64_tr_b16 v[6:7], v34 offset:256
    ds_read_b64_tr_b16 v[8:9], v35 offset:0
    ds_read_b64_tr_b16 v[10:11], v35 offset:256
    v_mfma_f32_32x32x16_bf16 v[64:79], v[48:51], v[188:191], v[64:79]
    s_add_u32 m0, s14, 43008
    s_add_u32 s27, s13, 39424
    buffer_load_dwordx4 v32, s[8:11], s27 offen lds
    v_mfma_f32_32x32x16_bf16 v[96:111], v[52:55], v[184:187], v[96:111]
    buffer_load_dwordx4 v33, s[8:11], s27 offen offset:1024 lds
    v_mfma_f32_32x32x16_bf16 v[112:127], v[52:55], v[188:191], v[112:127]
    s_waitcnt vmcnt(22)
    s_waitcnt lgkmcnt(0)
    v_mfma_f32_32x32x16_bf16 v[80:95], v[4:7], v[16:19], v[80:95]
    ds_read_b64_tr_b16 v[48:49], v34 offset:2048
    ds_read_b64_tr_b16 v[50:51], v34 offset:2304
    ds_read_b64_tr_b16 v[52:53], v35 offset:2048
    ds_read_b64_tr_b16 v[54:55], v35 offset:2304
    v_mfma_f32_32x32x16_bf16 v[64:79], v[4:7], v[20:23], v[64:79]
    s_add_u32 m0, s14, 0
    s_add_u32 s27, s13, 50176
    buffer_load_dwordx4 v32, s[8:11], s27 offen lds
    v_mfma_f32_32x32x16_bf16 v[96:111], v[8:11], v[16:19], v[96:111]
    buffer_load_dwordx4 v33, s[8:11], s27 offen offset:1024 lds
    v_mfma_f32_32x32x16_bf16 v[112:127], v[8:11], v[20:23], v[112:127]
    s_waitcnt vmcnt(22)
    s_waitcnt lgkmcnt(0)
    v_mfma_f32_32x32x16_bf16 v[80:95], v[48:51], v[24:27], v[80:95]
    ds_read_b64_tr_b16 v[4:5], v34 offset:4096
    ds_read_b64_tr_b16 v[6:7], v34 offset:4352
    ds_read_b64_tr_b16 v[8:9], v35 offset:4096
    ds_read_b64_tr_b16 v[10:11], v35 offset:4352
    v_mfma_f32_32x32x16_bf16 v[64:79], v[48:51], v[28:31], v[64:79]
    s_mov_b64 exec, 255
    buffer_load_dword v61, v37, s[28:31], 0 offen sc1
    s_mov_b64 exec, -1
    v_mfma_f32_32x32x16_bf16 v[96:111], v[52:55], v[24:27], v[96:111]
    s_add_u32 m0, s14, 2048
    s_add_u32 s27, s13, 64512
    buffer_load_dwordx4 v32, s[8:11], s27 offen lds
    v_mfma_f32_32x32x16_bf16 v[112:127], v[52:55], v[28:31], v[112:127]
    buffer_load_dwordx4 v33, s[8:11], s27 offen offset:1024 lds
    s_waitcnt vmcnt(23)
    s_waitcnt lgkmcnt(0)
    v_mfma_f32_32x32x16_bf16 v[80:95], v[4:7], v[128:131], v[80:95]
    ds_read_b64_tr_b16 v[48:49], v34 offset:6144
    ds_read_b64_tr_b16 v[50:51], v34 offset:6400
    ds_read_b64_tr_b16 v[52:53], v35 offset:6144
    ds_read_b64_tr_b16 v[54:55], v35 offset:6400
    v_mfma_f32_32x32x16_bf16 v[64:79], v[4:7], v[132:135], v[64:79]
    s_add_u32 m0, s14, 4096
    s_add_u32 s27, s13, 75264
    buffer_load_dwordx4 v32, s[8:11], s27 offen lds
    v_mfma_f32_32x32x16_bf16 v[96:111], v[8:11], v[128:131], v[96:111]
    buffer_load_dwordx4 v33, s[8:11], s27 offen offset:1024 lds
    v_mfma_f32_32x32x16_bf16 v[112:127], v[8:11], v[132:135], v[112:127]
    s_waitcnt vmcnt(23)
    s_waitcnt lgkmcnt(0)
    v_mfma_f32_32x32x16_bf16 v[80:95], v[48:51], v[136:139], v[80:95]
    ds_read_b64_tr_b16 v[4:5], v40 offset:0
    ds_read_b64_tr_b16 v[6:7], v40 offset:256
    ds_read_b64_tr_b16 v[8:9], v41 offset:0
    ds_read_b64_tr_b16 v[10:11], v41 offset:256
    v_mfma_f32_32x32x16_bf16 v[64:79], v[48:51], v[140:143], v[64:79]
    s_add_u32 m0, s14, 6144
    s_add_u32 s27, s13, 89600
    buffer_load_dwordx4 v32, s[8:11], s27 offen lds
    v_mfma_f32_32x32x16_bf16 v[96:111], v[52:55], v[136:139], v[96:111]
    buffer_load_dwordx4 v33, s[8:11], s27 offen offset:1024 lds
    v_mfma_f32_32x32x16_bf16 v[112:127], v[52:55], v[140:143], v[112:127]
    s_waitcnt vmcnt(23)
    s_waitcnt lgkmcnt(0)
    v_mfma_f32_32x32x16_bf16 v[80:95], v[4:7], v[144:147], v[80:95]
    ds_read_b64_tr_b16 v[48:49], v40 offset:2048
    ds_read_b64_tr_b16 v[50:51], v40 offset:2304
    ds_read_b64_tr_b16 v[52:53], v41 offset:2048
    ds_read_b64_tr_b16 v[54:55], v41 offset:2304
    v_mfma_f32_32x32x16_bf16 v[64:79], v[4:7], v[148:151], v[64:79]
    v_mfma_f32_32x32x16_bf16 v[96:111], v[8:11], v[144:147], v[96:111]
    v_mfma_f32_32x32x16_bf16 v[112:127], v[8:11], v[148:151], v[112:127]
    s_waitcnt vmcnt(21)
    s_waitcnt lgkmcnt(0)
    v_mfma_f32_32x32x16_bf16 v[80:95], v[48:51], v[152:155], v[80:95]
    ds_read_b64_tr_b16 v[4:5], v40 offset:4096
    ds_read_b64_tr_b16 v[6:7], v40 offset:4352
    ds_read_b64_tr_b16 v[8:9], v41 offset:4096
    ds_read_b64_tr_b16 v[10:11], v41 offset:4352
    v_mfma_f32_32x32x16_bf16 v[64:79], v[48:51], v[156:159], v[64:79]
    v_mfma_f32_32x32x16_bf16 v[96:111], v[52:55], v[152:155], v[96:111]
    v_mfma_f32_32x32x16_bf16 v[112:127], v[52:55], v[156:159], v[112:127]
    s_waitcnt vmcnt(6)
    v_cmp_ne_u32 s[88:89], s47, v61
    s_nop 0
    s_and_b32 s88, s88, 255
    s_cbranch_scc0 G_OKO
    s_mov_b32 s27, 65536
    s_mov_b32 exec_lo, s88
    s_mov_b32 exec_hi, 0
    s_branch G_PO_L
G_PO:
    s_mov_b64 exec, s[88:89]
    s_sleep 3
G_PO_L:
    buffer_load_dword v61, v37, s[28:31], 0 offen sc1
    s_waitcnt vmcnt(0)
    v_cmp_ne_u32 s[88:89], s47, v61
    s_sub_u32 s27, s27, 1
    s_cbranch_scc1 G_PO_X
    s_cmp_lg_u64 s[88:89], 0
    s_cbranch_scc1 G_PO
G_PO_X:
    s_mov_b64 exec, -1
G_OKO:
    s_waitcnt lgkmcnt(0)
    v_mfma_f32_32x32x16_bf16 v[80:95], v[4:7], v[160:163], v[80:95]
    ds_read_b64_tr_b16 v[48:49], v40 offset:6144
    ds_read_b64_tr_b16 v[50:51], v40 offset:6400
    ds_read_b64_tr_b16 v[52:53], v41 offset:6144
    ds_read_b64_tr_b16 v[54:55], v41 offset:6400
    v_mfma_f32_32x32x16_bf16 v[64:79], v[4:7], v[164:167], v[64:79]
    buffer_load_dwordx4 v[192:195], v13, s[28:31], s46 offen offset:0 sc1
    buffer_load_dwordx4 v[196:199], v13, s[28:31], s100 offen offset:0 sc1
    v_mfma_f32_32x32x16_bf16 v[96:111], v[8:11], v[160:163], v[96:111]
    buffer_load_dwordx4 v[200:203], v13, s[28:31], s46 offen offset:1024 sc1
    buffer_load_dwordx4 v[204:207], v13, s[28:31], s100 offen offset:1024 sc1
    v_mfma_f32_32x32x16_bf16 v[112:127], v[8:11], v[164:167], v[112:127]
    buffer_load_dwordx4 v[208:211], v13, s[28:31], s46 offen offset:2048 sc1
    buffer_load_dwordx4 v[212:215], v13, s[28:31], s100 offen offset:2048 sc1
    s_waitcnt lgkmcnt(0)
    v_mfma_f32_32x32x16_bf16 v[80:95], v[48:51], v[168:171], v[80:95]
    ds_read_b64_tr_b16 v[4:5], v34 offset:36864
    ds_read_b64_tr_b16 v[6:7], v34 offset:37120
    ds_read_b64_tr_b16 v[8:9], v35 offset:36864
    ds_read_b64_tr_b16 v[10:11], v35 offset:37120
    v_mfma_f32_32x32x16_bf16 v[64:79], v[48:51], v[172:175], v[64:79]
    buffer_load_dwordx4 v[216:219], v13, s[28:31], s46 offen offset:3072 sc1
    buffer_load_dwordx4 v[220:223], v13, s[28:31], s100 offen offset:3072 sc1
    v_mfma_f32_32x32x16_bf16 v[96:111], v[52:55], v[168:171], v[96:111]
    s_add_u32 s46, s46, 4096
    s_add_u32 s100, s100, 4096
    buffer_load_dwordx4 v[224:227], v13, s[28:31], s46 offen offset:0 sc1
    buffer_load_dwordx4 v[228:231], v13, s[28:31], s100 offen offset:0 sc1
    v_mfma_f32_32x32x16_bf16 v[112:127], v[52:55], v[172:175], v[112:127]
    buffer_load_dwordx4 v[232:235], v13, s[28:31], s46 offen offset:1024 sc1
    buffer_load_dwordx4 v[236:239], v13, s[28:31], s100 offen offset:1024 sc1
    s_waitcnt vmcnt(10)
    s_waitcnt lgkmcnt(0)
    v_mfma_f32_32x32x16_bf16 v[80:95], v[4:7], v[192:195], v[80:95]
    ds_read_b64_tr_b16 v[48:49], v34 offset:38912
    ds_read_b64_tr_b16 v[50:51], v34 offset:39168
    ds_read_b64_tr_b16 v[52:53], v35 offset:38912
    ds_read_b64_tr_b16 v[54:55], v35 offset:39168
    v_mfma_f32_32x32x16_bf16 v[64:79], v[4:7], v[196:199], v[64:79]
    buffer_load_dwordx4 v[240:243], v13, s[28:31], s46 offen offset:2048 sc1
    buffer_load_dwordx4 v[244:247], v13, s[28:31], s100 offen offset:2048 sc1
    v_mfma_f32_32x32x16_bf16 v[96:111], v[8:11], v[192:195], v[96:111]
    buffer_load_dwordx4 v[248:251], v13, s[28:31], s46 offen offset:3072 sc1
    buffer_load_dwordx4 v[252:255], v13, s[28:31], s100 offen offset:3072 sc1
    v_mfma_f32_32x32x16_bf16 v[112:127], v[8:11], v[196:199], v[112:127]
    s_waitcnt vmcnt(12)
    s_waitcnt lgkmcnt(0)
    v_mfma_f32_32x32x16_bf16 v[80:95], v[48:51], v[200:203], v[80:95]
    ds_read_b64_tr_b16 v[4:5], v34 offset:40960
    ds_read_b64_tr_b16 v[6:7], v34 offset:41216
    ds_read_b64_tr_b16 v[8:9], v35 offset:40960
    ds_read_b64_tr_b16 v[10:11], v35 offset:41216
    v_mfma_f32_32x32x16_bf16 v[64:79], v[48:51], v[204:207], v[64:79]
    v_mfma_f32_32x32x16_bf16 v[96:111], v[52:55], v[200:203], v[96:111]
    v_mfma_f32_32x32x16_bf16 v[112:127], v[52:55], v[204:207], v[112:127]
    s_waitcnt vmcnt(10)
    s_waitcnt lgkmcnt(0)
    v_mfma_f32_32x32x16_bf16 v[80:95], v[4:7], v[208:211], v[80:95]
    ds_read_b64_tr_b16 v[48:49], v34 offset:43008
    ds_read_b64_tr_b16 v[50:51], v34 offset:43264
    ds_read_b64_tr_b16 v[52:53], v35 offset:43008
    ds_read_b64_tr_b16 v[54:55], v35 offset:43264
    v_mfma_f32_32x32x16_bf16 v[64:79], v[4:7], v[212:215], v[64:79]
    v_mfma_f32_32x32x16_bf16 v[96:111], v[8:11], v[208:211], v[96:111]
    v_mfma_f32_32x32x16_bf16 v[112:127], v[8:11], v[212:215], v[112:127]
    s_waitcnt vmcnt(8)
    s_waitcnt lgkmcnt(0)
    v_mfma_f32_32x32x16_bf16 v[80:95], v[48:51], v[216:219], v[80:95]
    ds_read_b64_tr_b16 v[4:5], v34 offset:0
    ds_read_b64_tr_b16 v[6:7], v34 offset:256
    ds_read_b64_tr_b16 v[8:9], v35 offset:0
    ds_read_b64_tr_b16 v[10:11], v35 offset:256
    v_mfma_f32_32x32x16_bf16 v[64:79], v[48:51], v[220:223], v[64:79]
    v_mfma_f32_32x32x16_bf16 v[96:111], v[52:55], v[216:219], v[96:111]
    v_mfma_f32_32x32x16_bf16 v[112:127], v[52:55], v[220:223], v[112:127]
    s_waitcnt vmcnt(6)
    s_waitcnt lgkmcnt(0)
    v_mfma_f32_32x32x16_bf16 v[80:95], v[4:7], v[224:227], v[80:95]
    ds_read_b64_tr_b16 v[48:49], v34 offset:2048
    ds_read_b64_tr_b16 v[50:51], v34 offset:2304
    ds_read_b64_tr_b16 v[52:53], v35 offset:2048
    ds_read_b64_tr_b16 v[54:55], v35 offset:2304
    v_mfma_f32_32x32x16_bf16 v[64:79], v[4:7], v[228:231], v[64:79]
    v_mfma_f32_32x32x16_bf16 v[96:111], v[8:11], v[224:227], v[96:111]
    v_mfma_f32_32x32x16_bf16 v[112:127], v[8:11], v[228:231], v[112:127]
    s_waitcnt vmcnt(4)
    s_waitcnt lgkmcnt(0)
    v_mfma_f32_32x32x16_bf16 v[80:95], v[48:51], v[232:235], v[80:95]
    ds_read_b64_tr_b16 v[4:5], v34 offset:4096
    ds_read_b64_tr_b16 v[6:7], v34 offset:4352
    ds_read_b64_tr_b16 v[8:9], v35 offset:4096
    ds_read_b64_tr_b16 v[10:11], v35 offset:4352
    v_mfma_f32_32x32x16_bf16 v[64:79], v[48:51], v[236:239], v[64:79]
    v_mfma_f32_32x32x16_bf16 v[96:111], v[52:55], v[232:235], v[96:111]
    v_mfma_f32_32x32x16_bf16 v[112:127], v[52:55], v[236:239], v[112:127]
    s_waitcnt vmcnt(2)
    s_waitcnt lgkmcnt(0)
    v_mfma_f32_32x32x16_bf16 v[80:95], v[4:7], v[240:243], v[80:95]
    ds_read_b64_tr_b16 v[48:49], v34 offset:6144
    ds_read_b64_tr_b16 v[50:51], v34 offset:6400
    ds_read_b64_tr_b16 v[52:53], v35 offset:6144
    ds_read_b64_tr_b16 v[54:55], v35 offset:6400
    v_mfma_f32_32x32x16_bf16 v[64:79], v[4:7], v[244:247], v[64:79]
    v_mfma_f32_32x32x16_bf16 v[96:111], v[8:11], v[240:243], v[96:111]
    v_mfma_f32_32x32x16_bf16 v[112:127], v[8:11], v[244:247], v[112:127]
    s_waitcnt vmcnt(0)
    s_waitcnt lgkmcnt(0)
    v_mfma_f32_32x32x16_bf16 v[80:95], v[48:51], v[248:251], v[80:95]
    v_mfma_f32_32x32x16_bf16 v[64:79], v[48:51], v[252:255], v[64:79]
    v_mfma_f32_32x32x16_bf16 v[96:111], v[52:55], v[248:251], v[96:111]
    v_mfma_f32_32x32x16_bf16 v[112:127], v[52:55], v[252:255], v[112:127]
    s_nop 7
    s_nop 1
    ds_write_b128 v38, v[64:67] offset:0
    ds_write_b128 v38, v[68:71] offset:1024
    ds_write_b128 v38, v[72:75] offset:2048
    ds_write_b128 v38, v[76:79] offset:3072
    ds_write_b128 v38, v[96:99] offset:4096
    ds_write_b128 v38, v[100:103] offset:5120
    ds_write_b128 v38, v[104:107] offset:6144
    ds_write_b128 v38, v[108:111] offset:7168
    ds_write_b128 v38, v[112:115] offset:36864
    ds_write_b128 v38, v[116:119] offset:37888
    ds_write_b128 v38, v[120:123] offset:38912
    ds_write_b128 v38, v[124:127] offset:39936
    s_waitcnt lgkmcnt(0)
    s_barrier
    ds_read_b128 v[64:67], v45 offset:0
    ds_read_b128 v[68:71], v45 offset:1024
    ds_read_b128 v[72:75], v45 offset:2048
    ds_read_b128 v[76:79], v45 offset:3072
    ds_read_b128 v[96:99], v46 offset:4096
    ds_read_b128 v[100:103], v46 offset:5120
    ds_read_b128 v[104:107], v46 offset:6144
    ds_read_b128 v[108:111], v46 offset:7168
    ds_read_b128 v[112:115], v47 offset:36864
    ds_read_b128 v[116:119], v47 offset:37888
    ds_read_b128 v[120:123], v47 offset:38912
    ds_read_b128 v[124:127], v47 offset:39936
    s_waitcnt lgkmcnt(8)
    v_add_f32 v80, v80, v64
    v_add_f32 v81, v81, v65
    v_add_f32 v82, v82, v66
    v_add_f32 v83, v83, v67
    v_add_f32 v84, v84, v68
    v_add_f32 v85, v85, v69
    v_add_f32 v86, v86, v70
    v_add_f32 v87, v87, v71
    v_add_f32 v88, v88, v72
    v_add_f32 v89, v89, v73
    v_add_f32 v90, v90, v74
    v_add_f32 v91, v91, v75
    v_add_f32 v92, v92, v76
    v_add_f32 v93, v93, v77
    v_add_f32 v94, v94, v78
    v_add_f32 v95, v95, v79
    s_waitcnt lgkmcnt(4)
    v_add_f32 v80, v80, v96
    v_add_f32 v81, v81, v97
    v_add_f32 v82, v82, v98
    v_add_f32 v83, v83, v99
    v_add_f32 v84, v84, v100
    v_add_f32 v85, v85, v101
    v_add_f32 v86, v86, v102
    v_add_f32 v87, v87, v103
    v_add_f32 v88, v88, v104
    v_add_f32 v89, v89, v105
    v_add_f32 v90, v90, v106
    v_add_f32 v91, v91, v107
    v_add_f32 v92, v92, v108
    v_add_f32 v93, v93, v109
    v_add_f32 v94, v94, v110
    v_add_f32 v95, v95, v111
    s_waitcnt lgkmcnt(2)
    v_add_f32 v80, v80, v112
    v_add_f32 v81, v81, v113
    v_add_f32 v82, v82, v114
    v_add_f32 v83, v83, v115
    v_add_f32 v84, v84, v116
    v_add_f32 v85, v85, v117
    v_add_f32 v86, v86, v118
    v_add_f32 v87, v87, v119
    v_cvt_pk_bf16_f32 v16, v80, v81
    v_cvt_pk_bf16_f32 v17, v82, v83
    v_cvt_pk_bf16_f32 v18, v84, v85
    v_cvt_pk_bf16_f32 v19, v86, v87
    buffer_store_dwordx4 v[16:19], v44, s[20:23], s15 offen offset:0
    s_waitcnt lgkmcnt(0)
    v_add_f32 v88, v88, v120
    v_add_f32 v89, v89, v121
    v_add_f32 v90, v90, v122
    v_add_f32 v91, v91, v123
    v_add_f32 v92, v92, v124
    v_add_f32 v93, v93, v125
    v_add_f32 v94, v94, v126
    v_add_f32 v95, v95, v127
    v_cvt_pk_bf16_f32 v20, v88, v89
    v_cvt_pk_bf16_f32 v21, v90, v91
    v_cvt_pk_bf16_f32 v22, v92, v93
    v_cvt_pk_bf16_f32 v23, v94, v95
    buffer_store_dwordx4 v[20:23], v44, s[20:23], s15 offen offset:32
L_END:
    s_endpgm
L_CODE_END:
.section .rodata,"a"
.p2align 6
.amdhsa_kernel parallel_sum__sliding_block__dense_activation_gelu__prompt_kernel
  .amdhsa_next_free_vgpr 256
  .amdhsa_next_free_sgpr 102
  .amdhsa_accum_offset 256
  .amdhsa_group_segment_fixed_size 0
  .amdhsa_kernarg_size 88
  .amdhsa_user_sgpr_count 2
  .amdhsa_user_sgpr_kernarg_segment_ptr 1
  .amdhsa_system_sgpr_workgroup_id_x 1
.end_amdhsa_kernel
```
